```python
import torch

def _softmax(x, axis=-1):
    return torch.softmax(x, dim=axis)
def _gelu(x):
    return torch.nn.functional.gelu(x, approximate="tanh")
def _silu(x):
    return torch.nn.functional.silu(x)
def _sigmoid(x):
    return torch.sigmoid(x)
def _layernorm(x, axis=-1, eps=1e-5):
    m = x.mean(dim=axis, keepdim=True)
    v = x.var(dim=axis, keepdim=True, unbiased=False)
    return (x - m) / torch.sqrt(v + eps)
def _scatter_add(tgt, idx, src, axis=0):
    return tgt.clone().index_add_(axis, idx, src)
def _segment_sum(src, seg, n):
    out = torch.zeros((n,) + src.shape[1:], dtype=src.dtype)
    return out.index_add_(0, seg, src)
def _pad(x, pw):
    flat = tuple(v for pair in reversed(pw) for v in pair)
    return torch.nn.functional.pad(x, flat)

kernel_name = 'standalone__cheap_equivariant_egnn__graph'

def setup_inputs():

    _w = (lambda a: (lambda t: t.to(torch.bfloat16) if t.is_floating_point() else t)(torch.as_tensor(a)))
    N, deg, D, De = 10000, 16, 128, max(0, 1)
    E = N * deg
    return {
        "h": _w((lambda *s: torch.randn(*s, dtype=torch.bfloat16) * 0.2)(N, D)),
        "pos": _w((lambda *s: torch.randn(*s, dtype=torch.bfloat16) * 0.8)(N, 3)),
        "e_attr": _w((lambda *s: torch.randn(*s, dtype=torch.bfloat16) * 0.8)(E, De)),
        "src": _w((lambda lo, hi, *s: torch.randint(lo, hi, s))(0, N, E).to(torch.int64)),
        "dst": _w((lambda lo, hi, *s: torch.randint(lo, hi, s))(0, N, E).to(torch.int64)),
        "w_e": _w(0.1 * (lambda *s: torch.randn(*s, dtype=torch.bfloat16) * 0.8)(2 * D + 1 + De, D)),
        "w_x": _w(0.1 * (lambda *s: torch.randn(*s, dtype=torch.bfloat16) * 0.2)(D, 1)),
        "w_h": _w(0.1 * (lambda *s: torch.randn(*s, dtype=torch.bfloat16) * 0.2)(2 * D, D)),
    }

def reference(h, pos, e_attr, src, dst, w_e, w_x, w_h):
    N, D = h.shape[0], h.shape[1]
    diff = pos[dst] - pos[src]
    dist2 = torch.sum(diff * diff, axis=-1, keepdims=True)
    e_in = torch.concatenate([h[dst], h[src], dist2, e_attr], axis=-1)
    m_ij = _silu(e_in @ w_e)
    coord_scale = m_ij @ w_x
    pos_new = pos + _segment_sum(diff * coord_scale, dst, N)
    m_i = _segment_sum(m_ij, dst, N)
    h_new = h + _silu(torch.concatenate([h, m_i], axis=-1) @ w_h)
    return h_new, pos_new
```

```asm
; @launch grid=(250,1,1) block=(1024,1,1) lds=163776
.amdgcn_target "amdgcn-amd-amdhsa--gfx950"
.text
.globl standalone__cheap_equivariant_egnn__graph_kernel
.p2align 8
.type standalone__cheap_equivariant_egnn__graph_kernel,@function
standalone__cheap_equivariant_egnn__graph_kernel:
    s_cmp_ge_u32 s2, 250
    s_cbranch_scc1 L_end2
    s_memrealtime s[6:7]
    s_load_dwordx16 s[76:91], s[0:1], 0
    s_load_dwordx2 s[40:41], s[0:1], 80
    s_load_dwordx2 s[32:33], s[0:1], 64
    v_mov_b32 v15, v0
    v_lshrrev_b32 v8, 6, v0
    v_and_b32 v0, 63, v0
    v_readfirstlane_b32 s60, v8
    s_mov_b32 s10, 2560000
    s_mov_b32 s11, 0x20000
    s_mov_b32 s14, 60000
    s_mov_b32 s15, 0x20000
    s_mov_b32 s18, 320000
    s_mov_b32 s19, 0x20000
    s_mov_b32 s22, 640000
    s_mov_b32 s23, 0x20000
    s_mov_b32 s26, 640000
    s_mov_b32 s27, 0x20000
    s_mov_b32 s30, 256
    s_mov_b32 s31, 0x20000
    s_mov_b32 s34, 2560000
    s_mov_b32 s35, 0x20000
    s_mov_b32 s38, 60000
    s_mov_b32 s39, 0x20000
    s_mov_b32 s42, 268435456
    s_mov_b32 s43, 0x20000
    s_mov_b32 s46, 10000
    s_mov_b32 s47, 0x20000
    s_mov_b32 s50, 66048
    s_mov_b32 s51, 0x20000
    s_mov_b32 s54, 65536
    s_mov_b32 s55, 0x20000
    s_lshr_b32 s61, s60, 2
    s_and_b32 s62, s60, 3
    s_and_b32 s56, s60, 7
    s_and_b32 s57, s61, 1
    s_mov_b32 s63, 0
    s_mov_b32 s58, 0
    v_mov_b32 v24, 0
    v_mov_b32 v25, 0
    v_mov_b32 v26, 0
    v_mov_b32 v27, 0
    s_cmp_eq_u32 s60, 0
    s_cbranch_scc0 L_b0
    v_lshlrev_b32 v8, 4, v0
    v_add_u32 v8, 162432, v8
    s_mov_b64 exec, 0xff
    ds_write_b128 v8, v[24:27]
    v_mov_b32 v8, 163504
    s_mov_b64 exec, 1
    ds_write_b128 v8, v[24:27]
    s_mov_b64 exec, -1
    s_waitcnt lgkmcnt(0)
L_b0:
    s_barrier
    s_cmp_ge_u32 s60, 8
    s_cbranch_scc1 L_front
    s_setprio 2
    v_lshlrev_b32 v8, 4, v15
    v_add_u32 v9, 61440, v8
    v_cmp_lt_u32 vcc, 255, v15
    s_mov_b64 exec, vcc
    s_cbranch_execz L_notail
    ds_write_b128 v9, v[24:27]
L_notail:
    s_mov_b64 exec, -1
    s_cmp_ge_u32 s2, 157
    s_cbranch_scc1 L_notgemm
    v_lshrrev_b32 v16, 2, v0
    v_lshlrev_b32 v16, 8, v16
    v_and_b32 v21, 3, v0
    v_lshl_add_u32 v16, v21, 4, v16
    s_lshl_b32 s64, s62, 6
    v_add_u32 v16, s64, v16
    v_lshrrev_b32 v21, 4, v0
    v_and_b32 v22, 15, v0
    v_xor_b32 v22, v22, v21
    s_and_b32 s64, s56, 1
    s_lshl_b32 s64, s64, 3
    v_xor_b32 v22, s64, v22
    v_lshlrev_b32 v22, 4, v22
    v_lshl_add_u32 v18, v21, 8, v22
    v_xor_b32 v19, 64, v18
    s_lshl_b32 s64, s62, 13
    s_lshl_b32 s65, s57, 12
    s_add_u32 s64, s64, s65
    s_add_u32 s64, s64, 69632
    s_lshl_b32 s65, s57, 14
    s_add_u32 s65, s65, 32768
    s_lshl_b32 s67, s56, 11
    s_lshl_b32 s96, s2, 14
    s_add_u32 s96, s96, s67
    s_waitcnt lgkmcnt(0)
    s_mov_b64 s[8:9], s[76:77]
    s_mov_b64 s[12:13], s[78:79]
    s_mov_b64 s[16:17], s[80:81]
    s_mov_b64 s[20:21], s[82:83]
    s_mov_b64 s[24:25], s[84:85]
    s_mov_b64 s[48:49], s[86:87]
    s_mov_b64 s[28:29], s[88:89]
    s_mov_b64 s[52:53], s[90:91]
    s_add_u32 s36, s32, 2560000
    s_addc_u32 s37, s33, 0
    s_add_u32 s44, s40, 8388608
    s_addc_u32 s45, s41, 16777216
    s_mov_b32 s92, s6
    s_add_u32 m0, s67, 102400
    s_add_u32 s97, s96, 1024
    buffer_load_dwordx4 v18, s[8:11], s96 offen lds
    s_add_u32 m0, s67, 103424
    s_nop 0
    buffer_load_dwordx4 v19, s[8:11], s97 offen lds
    s_add_u32 m0, s64, 0
    s_add_u32 s66, s65, 0
    buffer_load_dwordx4 v16, s[48:51], s66 offen lds
    s_add_u32 m0, s64, 1024
    s_add_u32 s66, s65, 4096
    buffer_load_dwordx4 v16, s[48:51], s66 offen lds
    s_add_u32 m0, s64, 2048
    s_add_u32 s66, s65, 8192
    buffer_load_dwordx4 v16, s[48:51], s66 offen lds
    s_add_u32 m0, s64, 3072
    s_add_u32 s66, s65, 12288
    buffer_load_dwordx4 v16, s[48:51], s66 offen lds
    v_lshrrev_b32 v21, 5, v0
    v_bfe_u32 v22, v0, 2, 2
    v_lshl_add_u32 v17, v21, 3, v22
    v_lshlrev_b32 v17, 6, v17
    v_bfe_u32 v21, v0, 4, 1
    v_lshl_add_u32 v17, v21, 5, v17
    v_and_b32 v21, 3, v0
    v_lshl_add_u32 v17, v21, 3, v17
    s_lshl_b32 s64, s62, 13
    s_add_u32 s64, s64, 69632
    v_add_u32 v17, s64, v17
    v_and_b32 v21, 31, v0
    v_lshrrev_b32 v22, 5, v0
    v_and_b32 v19, 15, v0
    v_xor_b32 v19, v19, v22
    v_lshlrev_b32 v19, 4, v19
    v_lshl_add_u32 v19, v21, 8, v19
    s_lshl_b32 s64, s57, 13
    s_add_u32 s64, s64, 102400
    v_add_u32 v19, s64, v19
    s_lshl_b32 s64, s56, 11
    s_add_u32 s64, s64, 118784
    v_bfe_u32 v18, v0, 2, 2
    v_lshlrev_b32 v18, 4, v18
    v_lshl_add_u32 v18, v21, 6, v18
    v_lshl_add_u32 v18, v22, 3, v18
    v_add_u32 v18, s64, v18
    v_lshrrev_b32 v21, 2, v0
    v_and_b32 v22, 3, v0
    v_bfe_u32 v16, v0, 4, 2
    v_xor_b32 v16, v16, v22
    v_lshlrev_b32 v16, 4, v16
    v_lshl_add_u32 v16, v21, 6, v16
    v_add_u32 v16, s64, v16
    v_lshlrev_b32 v20, 4, v22
    v_lshl_add_u32 v20, v21, 8, v20
    s_lshl_b32 s64, s2, 14
    s_lshl_b32 s65, s57, 13
    s_add_u32 s64, s64, s65
    s_lshl_b32 s65, s62, 6
    s_add_u32 s95, s64, s65
    s_add_u32 s95, s95, 8388608
    s_waitcnt vmcnt(0) lgkmcnt(0)
    v_mov_b32 v23, 162500
    v_mov_b32 v22, 1
    s_mov_b64 exec, 1
    ds_add_u32 v23, v22
    s_mov_b64 exec, -1
    v_mov_b32 v23, 162496
    v_mov_b32 v22, 1
    s_mov_b64 exec, 1
    ds_add_u32 v23, v22
    s_mov_b64 exec, -1
    v_mov_b32 v23, 162500
L_sy0:
    ds_read_b32 v22, v23
    s_waitcnt lgkmcnt(0)
    v_readfirstlane_b32 s64, v22
    s_cmp_ge_u32 s64, 8
    s_cbranch_scc1 L_syd0
    s_sleep 1
    s_branch L_sy0
L_syd0:
    v_xor_b32 v21, 0, v19
    ds_read_b128 v[56:59], v21
    ds_read_b64_tr_b16 v[24:25], v17 offset:0
    ds_read_b64_tr_b16 v[26:27], v17 offset:256
    v_xor_b32 v21, 32, v19
    ds_read_b128 v[60:63], v21
    ds_read_b64_tr_b16 v[28:29], v17 offset:1024
    ds_read_b64_tr_b16 v[30:31], v17 offset:1280
    v_xor_b32 v21, 64, v19
    ds_read_b128 v[64:67], v21
    ds_read_b64_tr_b16 v[32:33], v17 offset:2048
    ds_read_b64_tr_b16 v[34:35], v17 offset:2304
    v_xor_b32 v21, 96, v19
    ds_read_b128 v[68:71], v21
    ds_read_b64_tr_b16 v[36:37], v17 offset:3072
    ds_read_b64_tr_b16 v[38:39], v17 offset:3328
    v_xor_b32 v21, 128, v19
    ds_read_b128 v[72:75], v21
    ds_read_b64_tr_b16 v[40:41], v17 offset:4096
    ds_read_b64_tr_b16 v[42:43], v17 offset:4352
    v_xor_b32 v21, 160, v19
    ds_read_b128 v[76:79], v21
    ds_read_b64_tr_b16 v[44:45], v17 offset:5120
    ds_read_b64_tr_b16 v[46:47], v17 offset:5376
    v_xor_b32 v21, 192, v19
    ds_read_b128 v[80:83], v21
    ds_read_b64_tr_b16 v[48:49], v17 offset:6144
    ds_read_b64_tr_b16 v[50:51], v17 offset:6400
    v_xor_b32 v21, 224, v19
    ds_read_b128 v[84:87], v21
    ds_read_b64_tr_b16 v[52:53], v17 offset:7168
    ds_read_b64_tr_b16 v[54:55], v17 offset:7424
    s_waitcnt lgkmcnt(15)
    v_mfma_f32_32x32x16_bf16 v[88:103], v[24:27], v[56:59], 0
    s_waitcnt lgkmcnt(15)
    v_mfma_f32_32x32x16_bf16 v[88:103], v[28:31], v[60:63], v[88:103]
    s_waitcnt lgkmcnt(15)
    v_mfma_f32_32x32x16_bf16 v[88:103], v[32:35], v[64:67], v[88:103]
    s_waitcnt lgkmcnt(12)
    v_mfma_f32_32x32x16_bf16 v[88:103], v[36:39], v[68:71], v[88:103]
    s_waitcnt lgkmcnt(9)
    v_mfma_f32_32x32x16_bf16 v[88:103], v[40:43], v[72:75], v[88:103]
    s_waitcnt lgkmcnt(6)
    v_mfma_f32_32x32x16_bf16 v[88:103], v[44:47], v[76:79], v[88:103]
    s_waitcnt lgkmcnt(3)
    v_mfma_f32_32x32x16_bf16 v[88:103], v[48:51], v[80:83], v[88:103]
    s_waitcnt lgkmcnt(0)
    v_mfma_f32_32x32x16_bf16 v[88:103], v[52:55], v[84:87], v[88:103]
    v_mov_b32 v23, 162516
    v_mov_b32 v22, 1
    s_mov_b64 exec, 1
    ds_add_u32 v23, v22
    s_mov_b64 exec, -1
    s_mov_b32 s65, 0xbfb8aa3b
    s_nop 7
    s_nop 3
    v_mul_f32 v88, s65, v88
    v_mul_f32 v89, s65, v89
    v_mul_f32 v90, s65, v90
    v_mul_f32 v91, s65, v91
    v_cvt_pk_bf16_f32 v88, v88, v89
    v_cvt_pk_bf16_f32 v89, v90, v91
    v_xor_b32 v21, 0, v18
    ds_write_b64 v21, v[88:89]
    v_mul_f32 v92, s65, v92
    v_mul_f32 v93, s65, v93
    v_mul_f32 v94, s65, v94
    v_mul_f32 v95, s65, v95
    v_cvt_pk_bf16_f32 v92, v92, v93
    v_cvt_pk_bf16_f32 v93, v94, v95
    v_xor_b32 v21, 16, v18
    ds_write_b64 v21, v[92:93]
    v_mul_f32 v96, s65, v96
    v_mul_f32 v97, s65, v97
    v_mul_f32 v98, s65, v98
    v_mul_f32 v99, s65, v99
    v_cvt_pk_bf16_f32 v96, v96, v97
    v_cvt_pk_bf16_f32 v97, v98, v99
    v_xor_b32 v21, 32, v18
    ds_write_b64 v21, v[96:97]
    v_mul_f32 v100, s65, v100
    v_mul_f32 v101, s65, v101
    v_mul_f32 v102, s65, v102
    v_mul_f32 v103, s65, v103
    v_cvt_pk_bf16_f32 v100, v100, v101
    v_cvt_pk_bf16_f32 v101, v102, v103
    v_xor_b32 v21, 48, v18
    ds_write_b64 v21, v[100:101]
    s_waitcnt lgkmcnt(0)
    ds_read_b128 v[24:27], v16 offset:0
    ds_read_b128 v[28:31], v16 offset:1024
    s_add_u32 s65, s95, 4096
    s_waitcnt lgkmcnt(1)
    buffer_store_dwordx4 v[24:27], v20, s[40:43], s95 offen sc1
    s_waitcnt lgkmcnt(0)
    buffer_store_dwordx4 v[28:31], v20, s[40:43], s65 offen sc1
    s_mov_b32 s58, 8
    s_lshl_b32 s97, s2, 2
    s_add_u32 s97, s97, 13631488
    s_mov_b32 s70, 0x11111111
    s_mov_b32 s71, 0x11111111
    s_branch L_rfront
L_notgemm:
    s_cmp_ge_u32 s2, 220
    s_cbranch_scc1 L_notbin
    s_sub_u32 s95, s2, 157
    s_mul_i32 s64, s95, 10240
    v_lshlrev_b32 v54, 2, v15
    v_lshlrev_b32 v55, 1, v15
    v_lshlrev_b32 v57, 4, v15
    v_add_u32 v57, 69632, v57
    v_mov_b32 v56, 1
    s_add_u32 s66, s64, 4096
    s_add_u32 s65, s64, 8192
    s_lshr_b32 s96, s64, 1
    s_add_u32 s97, s96, 4096
    s_waitcnt lgkmcnt(0)
    s_mov_b64 s[8:9], s[76:77]
    s_mov_b64 s[12:13], s[78:79]
    s_mov_b64 s[16:17], s[80:81]
    s_mov_b64 s[20:21], s[82:83]
    s_mov_b64 s[24:25], s[84:85]
    s_mov_b64 s[48:49], s[86:87]
    s_mov_b64 s[28:29], s[88:89]
    s_mov_b64 s[52:53], s[90:91]
    s_add_u32 s36, s32, 2560000
    s_addc_u32 s37, s33, 0
    s_add_u32 s44, s40, 8388608
    s_addc_u32 s45, s41, 16777216
    s_mov_b32 s92, s6
    buffer_load_dword v24, v54, s[24:27], s64 offen offset:0
    buffer_load_dword v25, v54, s[24:27], s64 offen offset:2048
    buffer_load_dword v26, v54, s[24:27], s66 offen offset:0
    buffer_load_dword v27, v54, s[24:27], s66 offen offset:2048
    buffer_load_dword v28, v54, s[24:27], s65 offen offset:0
    buffer_load_dword v29, v54, s[20:23], s64 offen offset:0
    buffer_load_dword v30, v54, s[20:23], s64 offen offset:2048
    buffer_load_dword v31, v54, s[20:23], s66 offen offset:0
    buffer_load_dword v32, v54, s[20:23], s66 offen offset:2048
    buffer_load_dword v33, v54, s[20:23], s65 offen offset:0
    buffer_load_ushort v45, v55, s[16:19], s96 offen offset:0
    buffer_load_ushort v47, v55, s[16:19], s96 offen offset:1024
    buffer_load_ushort v49, v55, s[16:19], s96 offen offset:2048
    buffer_load_ushort v51, v55, s[16:19], s96 offen offset:3072
    buffer_load_ushort v53, v55, s[16:19], s97 offen offset:0
    v_mov_b32 v60, 0
    v_mov_b32 v61, 0
    v_mov_b32 v62, 0
    v_mov_b32 v63, 0
    ds_write_b128 v57, v[60:63] offset:0
    ds_write_b128 v57, v[60:63] offset:8192
    ds_write_b128 v57, v[60:63] offset:16384
    ds_write_b128 v57, v[60:63] offset:24576
    ds_write_b128 v57, v[60:63] offset:32768
    ds_write_b128 v57, v[60:63] offset:40960
    ds_write_b128 v57, v[60:63] offset:49152
    ds_write_b128 v57, v[60:63] offset:57344
    v_mov_b32 v23, 162500
    v_mov_b32 v22, 1
    s_mov_b64 exec, 1
    ds_add_u32 v23, v22
    s_mov_b64 exec, -1
    v_add_u32 v54, s64, v54
    s_mov_b32 s96, 640000
    v_cmp_gt_u32 s[76:77], s96, v54
    s_mov_b32 s96, 637952
    v_cmp_gt_u32 s[78:79], s96, v54
    s_mov_b32 s96, 635904
    v_cmp_gt_u32 s[80:81], s96, v54
    s_mov_b32 s96, 633856
    v_cmp_gt_u32 s[82:83], s96, v54
    s_mov_b32 s96, 631808
    v_cmp_gt_u32 s[84:85], s96, v54
    s_mov_b32 s96, 133632
    s_mov_b32 s97, 69632
    s_mov_b32 s86, -40
    s_mov_b32 s87, 31872
    s_mov_b32 s67, 1048576
    v_mov_b32 v23, 162500
L_sy1:
    ds_read_b32 v22, v23
    s_waitcnt lgkmcnt(0)
    v_readfirstlane_b32 s98, v22
    s_cmp_ge_u32 s98, 8
    s_cbranch_scc1 L_syd1
    s_sleep 1
    s_branch L_sy1
L_syd1:
    s_waitcnt vmcnt(14)
    v_mul_u32_u24 v34, 52429, v24
    v_lshrrev_b32 v34, 21, v34
    v_lshl_add_u32 v21, v34, 2, s96
    s_mov_b64 exec, s[76:77]
    ds_add_rtn_u32 v39, v21, v56
    v_mad_i32_i24 v24, v34, s86, v24
    v_lshl_add_u32 v34, v34, 7, s97
    v_lshlrev_b32 v24, 14, v24
    s_mov_b64 exec, -1
    s_waitcnt vmcnt(13)
    v_mul_u32_u24 v35, 52429, v25
    v_lshrrev_b32 v35, 21, v35
    v_lshl_add_u32 v21, v35, 2, s96
    s_mov_b64 exec, s[78:79]
    ds_add_rtn_u32 v40, v21, v56
    v_mad_i32_i24 v25, v35, s86, v25
    v_lshl_add_u32 v35, v35, 7, s97
    v_lshlrev_b32 v25, 14, v25
    s_mov_b64 exec, -1
    s_waitcnt vmcnt(12)
    v_mul_u32_u24 v36, 52429, v26
    v_lshrrev_b32 v36, 21, v36
    v_lshl_add_u32 v21, v36, 2, s96
    s_mov_b64 exec, s[80:81]
    ds_add_rtn_u32 v41, v21, v56
    v_mad_i32_i24 v26, v36, s86, v26
    v_lshl_add_u32 v36, v36, 7, s97
    v_lshlrev_b32 v26, 14, v26
    s_mov_b64 exec, -1
    s_waitcnt vmcnt(11)
    v_mul_u32_u24 v37, 52429, v27
    v_lshrrev_b32 v37, 21, v37
    v_lshl_add_u32 v21, v37, 2, s96
    s_mov_b64 exec, s[82:83]
    ds_add_rtn_u32 v42, v21, v56
    v_mad_i32_i24 v27, v37, s86, v27
    v_lshl_add_u32 v37, v37, 7, s97
    v_lshlrev_b32 v27, 14, v27
    s_mov_b64 exec, -1
    s_waitcnt vmcnt(10)
    v_mul_u32_u24 v38, 52429, v28
    v_lshrrev_b32 v38, 21, v38
    v_lshl_add_u32 v21, v38, 2, s96
    s_mov_b64 exec, s[84:85]
    ds_add_rtn_u32 v43, v21, v56
    v_mad_i32_i24 v28, v38, s86, v28
    v_lshl_add_u32 v38, v38, 7, s97
    v_lshlrev_b32 v28, 14, v28
    s_mov_b64 exec, -1
    s_waitcnt vmcnt(9)
    v_or3_b32 v44, v24, v29, s67
    s_waitcnt vmcnt(8)
    v_or3_b32 v46, v25, v30, s67
    s_waitcnt vmcnt(7)
    v_or3_b32 v48, v26, v31, s67
    s_waitcnt vmcnt(6)
    v_or3_b32 v50, v27, v32, s67
    s_waitcnt vmcnt(5)
    v_or3_b32 v52, v28, v33, s67
    s_waitcnt vmcnt(0) lgkmcnt(0)
    v_mov_b32 v23, 162496
    v_mov_b32 v22, 1
    s_mov_b64 exec, 1
    ds_add_u32 v23, v22
    s_mov_b64 exec, -1
    v_lshl_add_u32 v21, v39, 3, v34
    v_lshrrev_b32 v22, 4, v39
    s_mov_b64 exec, s[76:77]
    v_cmp_gt_u32 vcc, 32, v39
    v_mad_u32_u24 v21, v22, s87, v21
    s_mov_b64 exec, vcc
    ds_write_b64 v21, v[44:45]
    s_mov_b64 exec, -1
    v_lshl_add_u32 v21, v40, 3, v35
    v_lshrrev_b32 v22, 4, v40
    s_mov_b64 exec, s[78:79]
    v_cmp_gt_u32 vcc, 32, v40
    v_mad_u32_u24 v21, v22, s87, v21
    s_mov_b64 exec, vcc
    ds_write_b64 v21, v[46:47]
    s_mov_b64 exec, -1
    v_lshl_add_u32 v21, v41, 3, v36
    v_lshrrev_b32 v22, 4, v41
    s_mov_b64 exec, s[80:81]
    v_cmp_gt_u32 vcc, 32, v41
    v_mad_u32_u24 v21, v22, s87, v21
    s_mov_b64 exec, vcc
    ds_write_b64 v21, v[48:49]
    s_mov_b64 exec, -1
    v_lshl_add_u32 v21, v42, 3, v37
    v_lshrrev_b32 v22, 4, v42
    s_mov_b64 exec, s[82:83]
    v_cmp_gt_u32 vcc, 32, v42
    v_mad_u32_u24 v21, v22, s87, v21
    s_mov_b64 exec, vcc
    ds_write_b64 v21, v[50:51]
    s_mov_b64 exec, -1
    v_lshl_add_u32 v21, v43, 3, v38
    v_lshrrev_b32 v22, 4, v43
    s_mov_b64 exec, s[84:85]
    v_cmp_gt_u32 vcc, 32, v43
    v_mad_u32_u24 v21, v22, s87, v21
    s_mov_b64 exec, vcc
    ds_write_b64 v21, v[52:53]
    s_mov_b64 exec, -1
    s_waitcnt lgkmcnt(0)
    v_mov_b32 v23, 162504
    v_mov_b32 v22, 1
    s_mov_b64 exec, 1
    ds_add_u32 v23, v22
    s_mov_b64 exec, -1
    v_lshlrev_b32 v45, 4, v15
    v_lshrrev_b32 v47, 3, v15
    v_lshl_add_u32 v47, v47, 2, s96
    v_add_u32 v52, 69632, v45
    s_mul_i32 s64, s95, 32000
    s_bfe_u32 s65, s92, 589827
    s_xor_b32 s65, s65, 421
    s_lshl_b32 s65, s65, 23
    s_mov_b32 s97, 464
    v_cmp_gt_u32 s[72:73], s97, v15
    v_mov_b32 v43, 0
    v_mov_b32 v23, 162504
L_sy2:
    ds_read_b32 v22, v23
    s_waitcnt lgkmcnt(0)
    v_readfirstlane_b32 s98, v22
    s_cmp_ge_u32 s98, 8
    s_cbranch_scc1 L_syd2
    s_sleep 1
    s_branch L_sy2
L_syd2:
    ds_read_b128 v[24:27], v52 offset:0
    ds_read_b32 v40, v47 offset:0
    ds_read_b128 v[28:31], v52 offset:8192
    ds_read_b32 v41, v47 offset:256
    ds_read_b128 v[32:35], v52 offset:16384
    ds_read_b32 v42, v47 offset:512
    s_mov_b64 exec, s[72:73]
    ds_read_b128 v[36:39], v52 offset:24576
    ds_read_b32 v43, v47 offset:768
    s_mov_b64 exec, -1
    s_waitcnt lgkmcnt(6)
    v_add_u32 v21, 15, v40
    v_lshrrev_b32 v21, 4, v21
    v_min_u32 v21, 3, v21
    v_lshl_or_b32 v46, v21, 21, s65
    v_lshl_or_b32 v25, v27, 16, v25
    v_or_b32 v24, v24, v46
    v_or_b32 v26, v26, v46
    v_mov_b32 v27, s92
    buffer_store_dwordx4 v[24:27], v45, s[40:43], s64 offen sc1
    s_add_u32 s64, s64, 8192
    s_waitcnt lgkmcnt(4)
    v_add_u32 v21, 15, v41
    v_lshrrev_b32 v21, 4, v21
    v_min_u32 v21, 3, v21
    v_lshl_or_b32 v46, v21, 21, s65
    v_lshl_or_b32 v29, v31, 16, v29
    v_or_b32 v28, v28, v46
    v_or_b32 v30, v30, v46
    v_mov_b32 v31, s92
    buffer_store_dwordx4 v[28:31], v45, s[40:43], s64 offen sc1
    s_add_u32 s64, s64, 8192
    s_waitcnt lgkmcnt(2)
    v_add_u32 v21, 15, v42
    v_lshrrev_b32 v21, 4, v21
    v_min_u32 v21, 3, v21
    v_lshl_or_b32 v46, v21, 21, s65
    v_lshl_or_b32 v33, v35, 16, v33
    v_or_b32 v32, v32, v46
    v_or_b32 v34, v34, v46
    v_mov_b32 v35, s92
    buffer_store_dwordx4 v[32:35], v45, s[40:43], s64 offen sc1
    s_add_u32 s64, s64, 8192
    s_mov_b64 exec, s[72:73]
    s_waitcnt lgkmcnt(0)
    v_add_u32 v21, 15, v43
    v_lshrrev_b32 v21, 4, v21
    v_min_u32 v21, 3, v21
    v_lshl_or_b32 v46, v21, 21, s65
    v_lshl_or_b32 v37, v39, 16, v37
    v_or_b32 v36, v36, v46
    v_or_b32 v38, v38, v46
    v_mov_b32 v39, s92
    buffer_store_dwordx4 v[36:39], v45, s[40:43], s64 offen sc1
    s_add_u32 s64, s64, 8192
    s_mov_b64 exec, -1
    s_mul_i32 s64, s95, 32000
    s_add_u32 s64, s64, 4194304
    v_cmp_lt_u32 vcc, 16, v40
    s_mov_b64 exec, vcc
    s_cbranch_execz L_nob0
    ds_read_b128 v[48:51], v52 offset:32000
    s_waitcnt lgkmcnt(0)
    v_add_u32 v21, 15, v40
    v_lshrrev_b32 v21, 4, v21
    v_min_u32 v21, 3, v21
    v_lshl_or_b32 v46, v21, 21, s65
    v_lshl_or_b32 v49, v51, 16, v49
    v_or_b32 v48, v48, v46
    v_or_b32 v50, v50, v46
    v_mov_b32 v51, s92
    buffer_store_dwordx4 v[48:51], v45, s[40:43], s64 offen sc1
    s_nop 1
L_nob0:
    s_mov_b64 exec, -1
    s_add_u32 s64, s64, 8192
    v_cmp_lt_u32 vcc, 16, v41
    s_mov_b64 exec, vcc
    s_cbranch_execz L_nob1
    ds_read_b128 v[48:51], v52 offset:40192
    s_waitcnt lgkmcnt(0)
    v_add_u32 v21, 15, v41
    v_lshrrev_b32 v21, 4, v21
    v_min_u32 v21, 3, v21
    v_lshl_or_b32 v46, v21, 21, s65
    v_lshl_or_b32 v49, v51, 16, v49
    v_or_b32 v48, v48, v46
    v_or_b32 v50, v50, v46
    v_mov_b32 v51, s92
    buffer_store_dwordx4 v[48:51], v45, s[40:43], s64 offen sc1
    s_nop 1
L_nob1:
    s_mov_b64 exec, -1
    s_add_u32 s64, s64, 8192
    v_cmp_lt_u32 vcc, 16, v42
    s_mov_b64 exec, vcc
    s_cbranch_execz L_nob2
    ds_read_b128 v[48:51], v52 offset:48384
    s_waitcnt lgkmcnt(0)
    v_add_u32 v21, 15, v42
    v_lshrrev_b32 v21, 4, v21
    v_min_u32 v21, 3, v21
    v_lshl_or_b32 v46, v21, 21, s65
    v_lshl_or_b32 v49, v51, 16, v49
    v_or_b32 v48, v48, v46
    v_or_b32 v50, v50, v46
    v_mov_b32 v51, s92
    buffer_store_dwordx4 v[48:51], v45, s[40:43], s64 offen sc1
    s_nop 1
L_nob2:
    s_mov_b64 exec, -1
    s_add_u32 s64, s64, 8192
    v_cmp_lt_u32 vcc, 16, v43
    s_mov_b64 exec, vcc
    s_cbranch_execz L_nob3
    ds_read_b128 v[48:51], v52 offset:56576
    s_waitcnt lgkmcnt(0)
    v_add_u32 v21, 15, v43
    v_lshrrev_b32 v21, 4, v21
    v_min_u32 v21, 3, v21
    v_lshl_or_b32 v46, v21, 21, s65
    v_lshl_or_b32 v49, v51, 16, v49
    v_or_b32 v48, v48, v46
    v_or_b32 v50, v50, v46
    v_mov_b32 v51, s92
    buffer_store_dwordx4 v[48:51], v45, s[40:43], s64 offen sc1
    s_nop 1
L_nob3:
    s_mov_b64 exec, -1
    s_add_u32 s64, s64, 8192
    v_mov_b32 v23, 162516
    v_mov_b32 v22, 1
    s_mov_b64 exec, 1
    ds_add_u32 v23, v22
    s_mov_b64 exec, -1
    s_branch L_rfront
L_notbin:
    s_waitcnt lgkmcnt(0)
    s_mov_b64 s[8:9], s[76:77]
    s_mov_b64 s[12:13], s[78:79]
    s_mov_b64 s[16:17], s[80:81]
    s_mov_b64 s[20:21], s[82:83]
    s_mov_b64 s[24:25], s[84:85]
    s_mov_b64 s[48:49], s[86:87]
    s_mov_b64 s[28:29], s[88:89]
    s_mov_b64 s[52:53], s[90:91]
    s_add_u32 s36, s32, 2560000
    s_addc_u32 s37, s33, 0
    s_add_u32 s44, s40, 8388608
    s_addc_u32 s45, s41, 16777216
    s_mov_b32 s92, s6
    v_mov_b32 v23, 162496
    v_mov_b32 v22, 1
    s_mov_b64 exec, 1
    ds_add_u32 v23, v22
    s_mov_b64 exec, -1
    s_sub_u32 s95, s2, 220
    s_cmp_ge_u32 s95, 4
    s_cbranch_scc1 L_norole0
    v_lshrrev_b32 v16, 2, v0
    v_lshlrev_b32 v16, 8, v16
    v_and_b32 v21, 3, v0
    v_lshl_add_u32 v16, v21, 4, v16
    s_lshl_b32 s64, s95, 6
    v_add_u32 v16, s64, v16
    v_lshrrev_b32 v21, 5, v0
    v_bfe_u32 v22, v0, 2, 2
    v_lshl_add_u32 v17, v21, 3, v22
    v_lshlrev_b32 v17, 6, v17
    v_bfe_u32 v21, v0, 4, 1
    v_lshl_add_u32 v17, v21, 5, v17
    v_and_b32 v21, 3, v0
    v_lshl_add_u32 v17, v21, 3, v17
    s_lshl_b32 s66, s60, 10
    s_add_u32 s66, s66, 69632
    v_add_u32 v17, s66, v17
    v_lshlrev_b32 v20, 4, v0
    s_lshl_b32 s65, s60, 12
    s_add_u32 s65, s65, 32768
    s_mov_b32 m0, s66
    s_lshl_b32 s67, s95, 13
    buffer_load_dwordx4 v16, s[52:55], s65 offen lds
    s_lshl_b32 s64, s60, 10
    s_add_u32 s67, s67, s64
    s_add_u32 s67, s67, 12582912
    s_waitcnt vmcnt(0)
    ds_read_b64_tr_b16 v[24:25], v17
    ds_read_b64_tr_b16 v[26:27], v17 offset:256
    s_waitcnt lgkmcnt(0)
    buffer_store_dwordx4 v[24:27], v20, s[40:43], s67 offen sc1
    s_mov_b32 s58, 8
    s_lshl_b32 s97, s95, 2
    s_add_u32 s97, s97, 13632116
    s_mov_b32 s70, 0x11111111
    s_mov_b32 s71, 0x11111111
    s_cmp_eq_u32 s95, 3
    s_cbranch_scc0 L_wp_nopad
    s_mov_b32 s70, 0xffffffff
    s_mov_b32 s71, 0xffffffff
L_wp_nopad:
    s_branch L_norole
L_norole0:
    v_lshlrev_b32 v21, 16, v0
    s_mov_b32 exec_lo, -1
    s_mov_b32 exec_hi, 0xff
    s_cmp_eq_u32 s60, 0
    s_cbranch_scc0 L_tw1
    buffer_load_dword v24, v21, s[32:35], 0 offen
    buffer_load_dword v25, v21, s[36:39], 0 offen
    s_branch L_tw2
L_tw1:
    s_cmp_gt_u32 s60, 4
    s_cbranch_scc1 L_tw2
    s_mov_b32 s64, 0
    s_cmp_eq_u32 s60, 2
    s_cselect_b32 s64, 8388608, s64
    s_cmp_eq_u32 s60, 3
    s_cselect_b32 s64, 12582912, s64
    s_cmp_eq_u32 s60, 4
    s_cselect_b32 s64, 4194304, s64
    buffer_load_dword v24, v21, s[40:43], s64 offen
L_tw2:
    s_mov_b64 exec, -1
L_norole:
    v_mov_b32 v23, 162516
    v_mov_b32 v22, 1
    s_mov_b64 exec, 1
    ds_add_u32 v23, v22
    s_mov_b64 exec, -1
L_rfront:
    v_lshrrev_b32 v10, 2, v0
    v_lshlrev_b32 v10, 8, v10
    v_and_b32 v21, 3, v0
    v_lshl_add_u32 v10, v21, 4, v10
    s_lshl_b32 s64, s62, 6
    v_add_u32 v10, s64, v10
    s_lshl_b32 s66, s62, 13
    s_add_u32 s66, s66, 69632
    s_lshl_b32 s67, s57, 12
    s_add_u32 s67, s67, s66
    s_lshl_b32 s96, s57, 14
    v_mov_b32 v23, 162516
L_sy3:
    ds_read_b32 v22, v23
    s_waitcnt lgkmcnt(0)
    v_readfirstlane_b32 s98, v22
    s_cmp_ge_u32 s98, 8
    s_cbranch_scc1 L_syd3
    s_sleep 1
    s_branch L_sy3
L_syd3:
    s_add_u32 m0, s67, 0
    s_add_u32 s65, s96, 0
    buffer_load_dwordx4 v10, s[52:55], s65 offen lds
    s_add_u32 m0, s67, 1024
    s_add_u32 s65, s96, 4096
    buffer_load_dwordx4 v10, s[52:55], s65 offen lds
    s_add_u32 m0, s67, 2048
    s_add_u32 s65, s96, 8192
    buffer_load_dwordx4 v10, s[52:55], s65 offen lds
    s_add_u32 m0, s67, 3072
    s_add_u32 s65, s96, 12288
    buffer_load_dwordx4 v10, s[52:55], s65 offen lds
    s_mov_b32 s95, 0
    s_cmp_eq_u32 s58, 0
    s_cbranch_scc1 L_nosig
    s_waitcnt vmcnt(4)
    v_mov_b32 v21, 162472
    v_mov_b32 v22, 1
    s_mov_b64 exec, 1
    ds_add_rtn_u32 v18, v21, v22
    s_waitcnt lgkmcnt(0)
    s_mov_b64 exec, -1
    v_readfirstlane_b32 s64, v18
    s_xor_b32 s65, s92, 1515890085
    v_mov_b32 v22, s65
    v_lshrrev_b32 v21, 2, v0
    v_mul_u32_u24 v21, 1024, v21
    v_and_b32 v18, 3, v0
    v_lshl_add_u32 v21, v18, 2, v21
    s_add_u32 s64, s64, 1
    s_cmp_eq_u32 s64, s58
    s_cbranch_scc0 L_nosig
    s_mov_b64 exec, s[70:71]
    buffer_store_dword v22, v21, s[40:43], s97 offen sc1
    s_mov_b64 exec, -1
    s_mov_b32 s95, 1
L_nosig:
    s_setprio 0
    s_mov_b32 s96, s66
    s_lshr_b32 s76, s60, 1
    s_and_b32 s77, s60, 1
    s_mul_i32 s89, s76, 8704
    s_lshl_b32 s87, s60, 12
    s_add_u32 s87, s87, 69632
    s_add_u32 s88, s87, 2048
    v_lshrrev_b32 v11, 5, v0
    v_lshrrev_b32 v12, 3, v0
    v_lshlrev_b32 v1, 6, v12
    v_xor_b32 v12, 1, v11
    v_lshl_add_u32 v1, v12, 4, v1
    s_add_u32 s64, s89, 0
    v_add_u32 v1, s64, v1
    v_and_b32 v13, 7, v0
    v_bfe_u32 v14, v0, 4, 1
    v_lshlrev_b32 v12, 2, v14
    v_xor_b32 v13, v13, v12
    v_lshlrev_b32 v2, 4, v13
    s_lshl_b32 s65, s77, 7
    v_add_u32 v2, s65, v2
    v_bfe_u32 v12, v0, 2, 2
    v_and_b32 v13, 3, v0
    v_lshlrev_b32 v10, 5, v14
    v_lshl_add_u32 v10, v13, 3, v10
    v_lshl_add_u32 v3, v11, 3, v12
    v_lshl_add_u32 v3, v3, 7, v10
    v_bfe_u32 v13, v0, 3, 1
    v_lshl_add_u32 v3, v13, 6, v3
    v_add_u32 v3, s87, v3
    v_xor_b32 v4, 64, v3
    v_lshlrev_b32 v13, 4, v11
    v_xor_b32 v10, v10, v13
    v_lshl_add_u32 v5, v11, 2, v12
    v_lshl_add_u32 v5, v5, 6, v10
    v_add_u32 v5, s64, v5
    v_and_b32 v12, 15, v0
    v_bfe_u32 v13, v0, 2, 2
    v_lshlrev_b32 v12, 6, v12
    v_lshl_add_u32 v12, v13, 4, v12
    v_add_u32 v12, s64, v12
    v_cmp_eq_u32 vcc, v11, v14
    v_mov_b32 v13, 162480
    v_cndmask_b32 v6, v13, v12, vcc
    v_mov_b32 v12, 2048
    v_cndmask_b32 v7, 0, v12, vcc
    s_mov_b32 s84, 1
    s_mov_b32 s91, 0
    v_and_b32 v8, 31, v0
    v_lshrrev_b32 v9, 5, v0
    v_and_b32 v10, 7, v8
    v_add_u32 v10, 32, v10
    s_cmp_eq_u32 s61, 0
    s_cselect_b64 vcc, -1, 0
    v_cndmask_b32 v10, v10, v8, vcc
    v_mul_u32_u24 v13, 52, v10
    v_lshrrev_b32 v13, 8, v13
    v_and_b32 v12, 3, v10
    v_xor_b32 v126, v12, v9
    v_lshlrev_b32 v126, 4, v126
    v_lshl_add_u32 v126, v12, 8, v126
    v_bfe_u32 v12, v10, 2, 2
    v_lshl_add_u32 v126, v12, 6, v126
    v_lshl_add_u32 v126, v13, 13, v126
    v_add_u32 v126, 69632, v126
    v_and_b32 v8, 31, v0
    v_lshrrev_b32 v9, 5, v0
    s_mul_i32 s65, s2, 40
    s_cmp_eq_u32 s61, 0
    s_cbranch_scc0 L_far_br
    v_and_b32 v10, 15, v8
    s_lshl_b32 s64, s62, 2
    v_xor_b32 v10, s64, v10
    v_lshlrev_b32 v10, 4, v10
    v_lshl_add_u32 v10, v8, 8, v10
    v_lshl_add_u32 v10, v9, 3, v10
    v_add_u32 v125, 151552, v10
    v_add_u32 v124, s65, v8
    v_lshlrev_b32 v124, 8, v124
    v_lshl_add_u32 v124, v9, 3, v124
    s_lshl_b32 s64, s62, 6
    v_add_u32 v124, s64, v124
    s_branch L_far_dr
L_far_br:
    v_lshrrev_b32 v10, 3, v8
    s_lshl_b32 s64, s62, 2
    v_add_u32 v10, s64, v10
    v_lshlrev_b32 v11, 2, v9
    v_xor_b32 v10, v10, v11
    v_lshlrev_b32 v10, 4, v10
    v_lshl_add_u32 v10, v11, 8, v10
    v_and_b32 v9, 7, v8
    v_lshl_add_u32 v10, v9, 1, v10
    v_add_u32 v125, 159744, v10
    s_add_u32 s64, s65, 32
    v_add_u32 v124, s64, v11
    v_lshlrev_b32 v124, 8, v124
    v_lshl_add_u32 v124, v8, 1, v124
    s_lshl_b32 s64, s62, 6
    v_add_u32 v124, s64, v124
L_far_dr:
    v_lshrrev_b32 v8, 5, v0
    v_bfe_u32 v9, v0, 2, 2
    v_lshl_add_u32 v14, v8, 3, v9
    v_lshlrev_b32 v14, 6, v14
    v_bfe_u32 v8, v0, 4, 1
    v_lshl_add_u32 v14, v8, 5, v14
    v_and_b32 v8, 3, v0
    v_lshl_add_u32 v14, v8, 3, v14
    v_add_u32 v14, s96, v14
    v_lshrrev_b32 v11, 5, v0
    v_and_b32 v12, 31, v0
    s_lshl_b32 s64, s57, 5
    v_add_u32 v12, s64, v12
    v_min_u32 v12, 39, v12
    v_and_b32 v10, 15, v12
    v_xor_b32 v10, v10, v11
    v_lshlrev_b32 v10, 4, v10
    v_lshl_add_u32 v9, v12, 8, v10
    v_add_u32 v9, 151552, v9
    s_cmp_eq_u32 s95, 0
    s_cbranch_scc1 L_h1w0
    s_waitcnt vmcnt(1)
    s_branch L_h1w1
L_h1w0:
    s_waitcnt vmcnt(0)
L_h1w1:
    v_mov_b32 v23, 162524
    v_mov_b32 v22, 1
    s_mov_b64 exec, 1
    ds_add_u32 v23, v22
    s_mov_b64 exec, -1
    v_mov_b32 v23, 162508
L_sy4:
    ds_read_b32 v22, v23
    s_waitcnt lgkmcnt(0)
    v_readfirstlane_b32 s98, v22
    s_cmp_ge_u32 s98, 8
    s_cbranch_scc1 L_syd4
    s_sleep 1
    s_branch L_sy4
L_syd4:
    v_xor_b32 v10, 0, v9
    ds_read_b128 v[48:51], v10
    v_xor_b32 v10, 32, v9
    ds_read_b128 v[52:55], v10
    v_xor_b32 v10, 64, v9
    ds_read_b128 v[56:59], v10
    v_xor_b32 v10, 96, v9
    ds_read_b128 v[60:63], v10
    v_xor_b32 v10, 128, v9
    ds_read_b128 v[80:83], v10
    v_xor_b32 v10, 160, v9
    ds_read_b128 v[84:87], v10
    v_xor_b32 v10, 192, v9
    ds_read_b128 v[88:91], v10
    v_xor_b32 v10, 224, v9
    ds_read_b128 v[92:95], v10
    v_mov_b32 v23, 162524
L_sy5:
    ds_read_b32 v22, v23
    s_waitcnt lgkmcnt(0)
    v_readfirstlane_b32 s98, v22
    s_cmp_ge_u32 s98, 8
    s_cbranch_scc1 L_syd5
    s_sleep 1
    s_branch L_sy5
L_syd5:
    ds_read_b64_tr_b16 v[16:17], v14 offset:0
    ds_read_b64_tr_b16 v[18:19], v14 offset:256
    ds_read_b64_tr_b16 v[20:21], v14 offset:1024
    ds_read_b64_tr_b16 v[22:23], v14 offset:1280
    ds_read_b64_tr_b16 v[24:25], v14 offset:2048
    ds_read_b64_tr_b16 v[26:27], v14 offset:2304
    ds_read_b64_tr_b16 v[28:29], v14 offset:3072
    ds_read_b64_tr_b16 v[30:31], v14 offset:3328
    ds_read_b64_tr_b16 v[32:33], v14 offset:4096
    ds_read_b64_tr_b16 v[34:35], v14 offset:4352
    ds_read_b64_tr_b16 v[36:37], v14 offset:5120
    ds_read_b64_tr_b16 v[38:39], v14 offset:5376
    ds_read_b64_tr_b16 v[40:41], v14 offset:6144
    ds_read_b64_tr_b16 v[42:43], v14 offset:6400
    ds_read_b64_tr_b16 v[44:45], v14 offset:7168
    ds_read_b64_tr_b16 v[46:47], v14 offset:7424
    s_mov_b32 s82, 0xbfb8aa3b
    s_cmp_eq_u32 s57, 0
    s_cbranch_scc0 L_h1b
    s_waitcnt lgkmcnt(14)
    v_mfma_f32_32x32x16_bf16 v[64:79], v[16:19], v[48:51], 0
    s_waitcnt lgkmcnt(12)
    v_mfma_f32_32x32x16_bf16 v[64:79], v[20:23], v[52:55], v[64:79]
    s_waitcnt lgkmcnt(10)
    v_mfma_f32_32x32x16_bf16 v[64:79], v[24:27], v[56:59], v[64:79]
    s_waitcnt lgkmcnt(8)
    v_mfma_f32_32x32x16_bf16 v[64:79], v[28:31], v[60:63], v[64:79]
    s_waitcnt lgkmcnt(6)
    v_mfma_f32_32x32x16_bf16 v[64:79], v[32:35], v[80:83], v[64:79]
    s_waitcnt lgkmcnt(4)
    v_mfma_f32_32x32x16_bf16 v[64:79], v[36:39], v[84:87], v[64:79]
    s_waitcnt lgkmcnt(2)
    v_mfma_f32_32x32x16_bf16 v[64:79], v[40:43], v[88:91], v[64:79]
    s_waitcnt lgkmcnt(0)
    v_mfma_f32_32x32x16_bf16 v[64:79], v[44:47], v[92:95], v[64:79]
    s_nop 7
    s_nop 3
    v_mul_f32 v64, s82, v64
    v_mul_f32 v65, s82, v65
    v_mul_f32 v66, s82, v66
    v_mul_f32 v67, s82, v67
    v_mul_f32 v68, s82, v68
    v_mul_f32 v69, s82, v69
    v_mul_f32 v70, s82, v70
    v_mul_f32 v71, s82, v71
    v_mul_f32 v72, s82, v72
    v_mul_f32 v73, s82, v73
    v_mul_f32 v74, s82, v74
    v_mul_f32 v75, s82, v75
    v_mul_f32 v76, s82, v76
    v_mul_f32 v77, s82, v77
    v_mul_f32 v78, s82, v78
    v_mul_f32 v79, s82, v79
    s_branch L_h1d
L_h1b:
    s_waitcnt lgkmcnt(14)
    v_mfma_f32_32x32x16_bf16 v[96:111], v[48:51], v[16:19], 0
    s_waitcnt lgkmcnt(12)
    v_mfma_f32_32x32x16_bf16 v[96:111], v[52:55], v[20:23], v[96:111]
    s_waitcnt lgkmcnt(10)
    v_mfma_f32_32x32x16_bf16 v[96:111], v[56:59], v[24:27], v[96:111]
    s_waitcnt lgkmcnt(8)
    v_mfma_f32_32x32x16_bf16 v[96:111], v[60:63], v[28:31], v[96:111]
    s_waitcnt lgkmcnt(6)
    v_mfma_f32_32x32x16_bf16 v[96:111], v[80:83], v[32:35], v[96:111]
    s_waitcnt lgkmcnt(4)
    v_mfma_f32_32x32x16_bf16 v[96:111], v[84:87], v[36:39], v[96:111]
    s_waitcnt lgkmcnt(2)
    v_mfma_f32_32x32x16_bf16 v[96:111], v[88:91], v[40:43], v[96:111]
    s_waitcnt lgkmcnt(0)
    v_mfma_f32_32x32x16_bf16 v[96:111], v[92:95], v[44:47], v[96:111]
    s_nop 7
    s_nop 3
    v_mul_f32 v120, s82, v96
    v_mul_f32 v121, s82, v97
    v_mul_f32 v122, s82, v98
    v_mul_f32 v123, s82, v99
L_h1d:
    v_mov_b32 v23, 162544
    v_mov_b32 v22, 1
    s_mov_b64 exec, 1
    ds_add_u32 v23, v22
    s_mov_b64 exec, -1
    s_branch L_common
L_front:
    s_sub_u32 s98, s60, 8
    v_lshlrev_b32 v8, 4, v15
    v_lshrrev_b32 v12, 4, v0
    v_and_b32 v9, 15, v0
    v_xor_b32 v9, v9, v12
    s_lshl_b32 s65, s62, 2
    v_xor_b32 v9, s65, v9
    v_lshlrev_b32 v9, 4, v9
    v_lshl_add_u32 v9, v12, 8, v9
    v_lshrrev_b32 v10, 2, v0
    v_lshlrev_b32 v10, 8, v10
    v_and_b32 v21, 3, v0
    v_lshl_add_u32 v10, v21, 4, v10
    s_lshl_b32 s64, s62, 6
    v_add_u32 v10, s64, v10
    s_lshl_b32 s66, s62, 13
    s_mul_i32 s64, s2, 10240
    s_lshl_b32 s65, s98, 10
    s_add_u32 s64, s64, s65
    v_mul_u32_u24 v11, 6, v0
    v_and_b32 v13, 31, v0
    s_lshl_b32 s67, s62, 5
    v_add_u32 v13, s67, v13
    v_lshlrev_b32 v13, 1, v13
    s_waitcnt lgkmcnt(0)
    s_mov_b64 s[8:9], s[76:77]
    s_mov_b64 s[12:13], s[78:79]
    s_mov_b64 s[16:17], s[80:81]
    s_mov_b64 s[20:21], s[82:83]
    s_mov_b64 s[24:25], s[84:85]
    s_mov_b64 s[48:49], s[86:87]
    s_mov_b64 s[28:29], s[88:89]
    s_mov_b64 s[52:53], s[90:91]
    s_add_u32 s36, s32, 2560000
    s_addc_u32 s37, s33, 0
    s_add_u32 s44, s40, 8388608
    s_addc_u32 s45, s41, 16777216
    s_mov_b32 s92, s6
    s_add_u32 m0, s65, 151552
    s_nop 0
    buffer_load_dwordx4 v9, s[8:11], s64 offen lds
    s_cmp_ge_u32 s98, 2
    s_cbranch_scc1 L_f_no2
    s_add_u32 m0, s65, 159744
    s_add_u32 s64, s64, 8192
    buffer_load_dwordx4 v9, s[8:11], s64 offen lds
L_f_no2:
    s_cmp_eq_u32 s98, 2
    s_cbranch_scc0 L_f_nopos
    s_mul_i32 s64, s2, 240
    v_cmp_gt_u32 vcc, 40, v0
    s_mov_b64 exec, vcc
    buffer_load_ushort v116, v11, s[12:15], s64 offen offset:0
    buffer_load_ushort v117, v11, s[12:15], s64 offen offset:2
    buffer_load_ushort v118, v11, s[12:15], s64 offen offset:4
    s_mov_b64 exec, -1
L_f_nopos:
    s_lshr_b32 s65, s2, 3
    s_and_b32 s65, s65, 7
    s_lshl_b32 s65, s65, 3
    s_add_u32 s65, s65, s98
    s_mul_i32 s65, s65, 960
    v_lshlrev_b32 v15, 4, v0
    buffer_load_dwordx4 v[108:111], v15, s[12:15], s65 offen
    s_cmp_eq_u32 s98, 3
    s_cbranch_scc0 L_f_nowx
    s_mov_b32 m0, 163520
    v_lshlrev_b32 v15, 4, v0
    s_mov_b64 exec, 0xffff
    buffer_load_dwordx4 v15, s[28:31], 0 offen lds
    s_mov_b64 exec, -1
L_f_nowx:
    s_mov_b32 s65, 65536
    buffer_load_ushort v124, v13, s[48:51], s65 offen
    buffer_load_ushort v125, v13, s[48:51], s65 offen offset:256
    s_add_u32 s97, s66, 0
    s_lshl_b32 s67, s57, 12
    s_add_u32 s67, s67, s97
    s_lshl_b32 s96, s57, 14
    ds_write_b128 v8, v[24:27] offset:24576
    ds_write_b128 v8, v[24:27] offset:32768
    ds_write_b128 v8, v[24:27] offset:40960
    ds_write_b128 v8, v[24:27] offset:49152
    v_mov_b32 v23, 162496
L_sy6:
    ds_read_b32 v22, v23
    s_waitcnt lgkmcnt(0)
    v_readfirstlane_b32 s64, v22
    s_cmp_ge_u32 s64, 8
    s_cbranch_scc1 L_syd6
    s_sleep 1
    s_branch L_sy6
L_syd6:
    s_add_u32 m0, s67, 0
    s_add_u32 s65, s96, 0
    buffer_load_dwordx4 v10, s[48:51], s65 offen lds
    s_add_u32 m0, s67, 1024
    s_add_u32 s65, s96, 4096
    buffer_load_dwordx4 v10, s[48:51], s65 offen lds
    s_add_u32 m0, s67, 2048
    s_add_u32 s65, s96, 8192
    buffer_load_dwordx4 v10, s[48:51], s65 offen lds
    s_add_u32 m0, s67, 3072
    s_add_u32 s65, s96, 12288
    buffer_load_dwordx4 v10, s[48:51], s65 offen lds
    s_lshr_b32 s76, s60, 1
    s_and_b32 s77, s60, 1
    s_mul_i32 s89, s76, 8704
    s_lshl_b32 s87, s60, 12
    s_add_u32 s87, s87, 69632
    s_add_u32 s88, s87, 2048
    v_lshrrev_b32 v11, 5, v0
    v_lshrrev_b32 v12, 3, v0
    v_lshlrev_b32 v1, 6, v12
    v_xor_b32 v12, 1, v11
    v_lshl_add_u32 v1, v12, 4, v1
    s_add_u32 s64, s89, 0
    v_add_u32 v1, s64, v1
    v_and_b32 v13, 7, v0
    v_bfe_u32 v14, v0, 4, 1
    v_lshlrev_b32 v12, 2, v14
    v_xor_b32 v13, v13, v12
    v_lshlrev_b32 v2, 4, v13
    s_lshl_b32 s65, s77, 7
    v_add_u32 v2, s65, v2
    v_bfe_u32 v12, v0, 2, 2
    v_and_b32 v13, 3, v0
    v_lshlrev_b32 v10, 5, v14
    v_lshl_add_u32 v10, v13, 3, v10
    v_lshl_add_u32 v3, v11, 3, v12
    v_lshl_add_u32 v3, v3, 7, v10
    v_bfe_u32 v13, v0, 3, 1
    v_lshl_add_u32 v3, v13, 6, v3
    v_add_u32 v3, s87, v3
    v_xor_b32 v4, 64, v3
    v_lshlrev_b32 v13, 4, v11
    v_xor_b32 v10, v10, v13
    v_lshl_add_u32 v5, v11, 2, v12
    v_lshl_add_u32 v5, v5, 6, v10
    v_add_u32 v5, s64, v5
    v_and_b32 v12, 15, v0
    v_bfe_u32 v13, v0, 2, 2
    v_lshlrev_b32 v12, 6, v12
    v_lshl_add_u32 v12, v13, 4, v12
    v_add_u32 v12, s64, v12
    v_cmp_eq_u32 vcc, v11, v14
    v_mov_b32 v13, 162480
    v_cndmask_b32 v6, v13, v12, vcc
    v_mov_b32 v12, 2048
    v_cndmask_b32 v7, 0, v12, vcc
    s_mov_b32 s84, 1
    s_mov_b32 s91, 0
    s_waitcnt vmcnt(4)
    v_mov_b32 v23, 162508
    v_mov_b32 v22, 1
    s_mov_b64 exec, 1
    ds_add_u32 v23, v22
    s_mov_b64 exec, -1
    s_cmp_eq_u32 s98, 2
    s_cbranch_scc0 L_noptf
    v_lshlrev_b32 v116, 16, v116
    v_lshlrev_b32 v117, 16, v117
    v_lshlrev_b32 v118, 16, v118
    v_mov_b32 v119, 0
    v_lshlrev_b32 v8, 4, v0
    v_add_u32 v8, 161792, v8
    v_cmp_gt_u32 vcc, 40, v0
    s_mov_b64 exec, vcc
    ds_write_b128 v8, v[116:119]
    s_mov_b64 exec, -1
L_noptf:
    v_lshrrev_b32 v8, 5, v0
    v_bfe_u32 v9, v0, 2, 2
    v_lshl_add_u32 v14, v8, 3, v9
    v_lshlrev_b32 v14, 6, v14
    v_bfe_u32 v8, v0, 4, 1
    v_lshl_add_u32 v14, v8, 5, v14
    v_and_b32 v8, 3, v0
    v_lshl_add_u32 v14, v8, 3, v14
    v_add_u32 v14, s97, v14
    v_lshrrev_b32 v11, 5, v0
    v_and_b32 v8, 7, v0
    v_subrev_u32 v8, 3, v8
    v_max_i32 v8, 0, v8
    v_bfe_u32 v9, v0, 3, 2
    v_mad_u32_u24 v8, v9, 5, v8
    s_mul_i32 s64, s57, 20
    v_add_u32 v8, s64, v8
    v_and_b32 v10, 15, v8
    v_xor_b32 v10, v10, v11
    v_lshlrev_b32 v10, 4, v10
    v_lshl_add_u32 v9, v8, 8, v10
    v_add_u32 v9, 151552, v9
    s_mov_b32 s64, 0xbfb8aa3b
    s_mov_b32 s65, 0xffff0000
    v_lshlrev_b32 v116, 16, v124
    v_lshlrev_b32 v117, 16, v125
    v_mul_f32 v116, s64, v116
    v_mul_f32 v117, s64, v117
    v_cvt_pk_bf16_f32 v124, v116, v117
    v_lshlrev_b32 v118, 16, v124
    v_and_b32 v119, s65, v124
    v_sub_f32 v116, v116, v118
    v_sub_f32 v117, v117, v119
    v_cvt_pk_bf16_f32 v125, v116, v117
    v_and_b32 v126, 31, v0
    v_lshlrev_b32 v126, 4, v126
    v_lshl_add_u32 v126, v11, 3, v126
    s_lshl_b32 s64, s62, 9
    s_lshl_b32 s65, s57, 13
    s_add_u32 s64, s64, s65
    s_add_u32 s64, s64, 135168
    v_add_u32 v126, s64, v126
    v_cmp_gt_u32 vcc, 32, v0
    v_mov_b32 v127, 0xffff0000
    v_cndmask_b32 v127, -1, v127, vcc
    v_and_b32 v125, 0xffff, v125
    v_cndmask_b32 v125, 0, v125, vcc
    s_mov_b32 s82, 0xc338aa3b
    v_mov_b32 v116, 0
    v_mov_b32 v117, 0
    v_mov_b32 v118, 0
    v_mov_b32 v119, 0
    s_waitcnt vmcnt(0)
    v_mov_b32 v23, 162528
    v_mov_b32 v22, 1
    s_mov_b64 exec, 1
    ds_add_u32 v23, v22
    s_mov_b64 exec, -1
    s_lshl_b32 s64, s98, 3
    v_lshrrev_b32 v12, 3, v0
    v_add_u32 v12, s64, v12
    v_mul_u32_u24 v120, 32000, v12
    v_and_b32 v13, 7, v0
    v_lshl_add_u32 v120, v13, 4, v120
    v_lshlrev_b32 v8, 4, v0
    s_lshl_b32 s64, s98, 12
    v_add_u32 v8, s64, v8
    v_cmp_gt_u32 s[96:97], 63, v12
    s_lshl_b32 s66, s2, 7
    s_add_u32 s67, s66, 4194304
    s_mov_b64 s[98:99], s[96:97]
    s_mov_b64 s[68:69], s[96:97]
    s_sub_u32 s93, s92, 600
    s_mov_b32 s83, 8192
    s_mov_b32 s94, 0
    s_mov_b64 s[74:75], s[98:99]
    v_mov_b32 v23, 162528
L_sy7:
    ds_read_b32 v22, v23
    s_waitcnt lgkmcnt(0)
    v_readfirstlane_b32 s64, v22
    s_cmp_ge_u32 s64, 8
    s_cbranch_scc1 L_syd7
    s_sleep 1
    s_branch L_sy7
L_syd7:
    ds_read_b64_tr_b16 v[16:17], v14 offset:0
    ds_read_b64_tr_b16 v[18:19], v14 offset:256
    ds_read_b64_tr_b16 v[20:21], v14 offset:1024
    ds_read_b64_tr_b16 v[22:23], v14 offset:1280
    ds_read_b64_tr_b16 v[24:25], v14 offset:2048
    ds_read_b64_tr_b16 v[26:27], v14 offset:2304
    ds_read_b64_tr_b16 v[28:29], v14 offset:3072
    ds_read_b64_tr_b16 v[30:31], v14 offset:3328
    ds_read_b64_tr_b16 v[32:33], v14 offset:4096
    ds_read_b64_tr_b16 v[34:35], v14 offset:4352
    ds_read_b64_tr_b16 v[36:37], v14 offset:5120
    ds_read_b64_tr_b16 v[38:39], v14 offset:5376
    ds_read_b64_tr_b16 v[40:41], v14 offset:6144
    ds_read_b64_tr_b16 v[42:43], v14 offset:6400
    ds_read_b64_tr_b16 v[44:45], v14 offset:7168
    ds_read_b64_tr_b16 v[46:47], v14 offset:7424
    s_waitcnt lgkmcnt(0)
    v_mov_b32 v112, 162532
    v_mov_b32 v113, 1
    s_mov_b64 exec, 1
    ds_add_u32 v112, v113
    s_mov_b64 exec, -1
    v_mov_b32 v112, 162532
L_sy8:
    ds_read_b32 v113, v112
    s_waitcnt lgkmcnt(0)
    v_readfirstlane_b32 s64, v113
    s_cmp_ge_u32 s64, 8
    s_cbranch_scc1 L_syd8
    s_sleep 1
    s_branch L_sy8
L_syd8:
    ds_write_b128 v8, v[116:119] offset:0
    ds_write_b128 v8, v[116:119] offset:1024
    ds_write_b128 v8, v[116:119] offset:2048
    ds_write_b128 v8, v[116:119] offset:3072
    s_waitcnt lgkmcnt(0)
    v_mov_b32 v112, 162512
    v_mov_b32 v113, 1
    s_mov_b64 exec, 1
    ds_add_u32 v112, v113
    s_mov_b64 exec, -1
    s_setprio 2
    s_cmp_eq_u64 s[96:97], 0
    s_cbranch_scc1 L_rp_noa0
    s_mov_b64 exec, s[96:97]
    buffer_load_dwordx4 v[96:99], v120, s[40:43], s66 offen sc1
L_rp_noa0:
    s_cmp_eq_u64 s[74:75], 0
    s_cbranch_scc1 L_rp_nob0
    s_mov_b64 exec, s[74:75]
    buffer_load_dwordx4 v[100:103], v120, s[40:43], s67 offen sc1
L_rp_nob0:
    s_mov_b64 exec, -1
    v_xor_b32 v10, 0, v9
    ds_read_b128 v[48:51], v10
    v_xor_b32 v10, 32, v9
    ds_read_b128 v[52:55], v10
    v_xor_b32 v10, 64, v9
    ds_read_b128 v[56:59], v10
    v_xor_b32 v10, 96, v9
    ds_read_b128 v[60:63], v10
    v_xor_b32 v10, 128, v9
    ds_read_b128 v[80:83], v10
    v_xor_b32 v10, 160, v9
    ds_read_b128 v[84:87], v10
    v_xor_b32 v10, 192, v9
    ds_read_b128 v[88:91], v10
    v_xor_b32 v10, 224, v9
    ds_read_b128 v[92:95], v10
    s_waitcnt lgkmcnt(7)
    v_mfma_f32_32x32x16_bf16 v[64:79], v[48:51], v[16:19], 0
    s_waitcnt lgkmcnt(6)
    v_mfma_f32_32x32x16_bf16 v[64:79], v[52:55], v[20:23], v[64:79]
    s_waitcnt lgkmcnt(5)
    v_mfma_f32_32x32x16_bf16 v[64:79], v[56:59], v[24:27], v[64:79]
    s_waitcnt lgkmcnt(4)
    v_mfma_f32_32x32x16_bf16 v[64:79], v[60:63], v[28:31], v[64:79]
    s_waitcnt lgkmcnt(3)
    v_mfma_f32_32x32x16_bf16 v[64:79], v[80:83], v[32:35], v[64:79]
    s_waitcnt lgkmcnt(2)
    v_mfma_f32_32x32x16_bf16 v[64:79], v[84:87], v[36:39], v[64:79]
    s_waitcnt lgkmcnt(1)
    v_mfma_f32_32x32x16_bf16 v[64:79], v[88:91], v[40:43], v[64:79]
    s_waitcnt lgkmcnt(0)
    v_mfma_f32_32x32x16_bf16 v[64:79], v[92:95], v[44:47], v[64:79]
    v_cmp_gt_u32 vcc, 32, v0
    s_nop 7
    s_nop 3
    v_mul_f32 v64, s82, v64
    v_mul_f32 v65, s82, v65
    v_mul_f32 v66, s82, v66
    v_mul_f32 v67, s82, v67
    v_cvt_pk_bf16_f32 v64, v64, v65
    v_cvt_pk_bf16_f32 v65, v66, v67
    v_cndmask_b32 v64, v64, v124, vcc
    v_and_or_b32 v65, v65, v127, v125
    ds_write_b64 v126, v[64:65] offset:0
    v_mul_f32 v68, s82, v68
    v_mul_f32 v69, s82, v69
    v_mul_f32 v70, s82, v70
    v_mul_f32 v71, s82, v71
    v_cvt_pk_bf16_f32 v68, v68, v69
    v_cvt_pk_bf16_f32 v69, v70, v71
    v_cndmask_b32 v68, v68, v124, vcc
    v_and_or_b32 v69, v69, v127, v125
    ds_write_b64 v126, v[68:69] offset:2048
    v_mul_f32 v72, s82, v72
    v_mul_f32 v73, s82, v73
    v_mul_f32 v74, s82, v74
    v_mul_f32 v75, s82, v75
    v_cvt_pk_bf16_f32 v72, v72, v73
    v_cvt_pk_bf16_f32 v73, v74, v75
    v_cndmask_b32 v72, v72, v124, vcc
    v_and_or_b32 v73, v73, v127, v125
    ds_write_b64 v126, v[72:73] offset:4096
    v_mul_f32 v76, s82, v76
    v_mul_f32 v77, s82, v77
    v_mul_f32 v78, s82, v78
    v_mul_f32 v79, s82, v79
    v_cvt_pk_bf16_f32 v76, v76, v77
    v_cvt_pk_bf16_f32 v77, v78, v79
    v_cndmask_b32 v76, v76, v124, vcc
    v_and_or_b32 v77, v77, v127, v125
    ds_write_b64 v126, v[76:77] offset:6144
    v_and_b32 v8, 1, v0
    v_lshlrev_b32 v8, 4, v8
    v_mov_b32 v9, 0x3f80
    v_lshlrev_b32 v8, v8, v9
    s_mov_b32 vcc_lo, 0x3
    s_mov_b32 vcc_hi, 0x300
    v_cndmask_b32 v104, 0, v8, vcc
    s_mov_b32 vcc_lo, 0xc
    s_mov_b32 vcc_hi, 0xc00
    v_cndmask_b32 v105, 0, v8, vcc
    s_mov_b32 vcc_lo, 0x30
    s_mov_b32 vcc_hi, 0x3000
    v_cndmask_b32 v106, 0, v8, vcc
    s_mov_b32 vcc_lo, 0xc0
    s_mov_b32 vcc_hi, 0xc000
    v_cndmask_b32 v107, 0, v8, vcc
    s_mov_b32 vcc_lo, 0x30000
    s_mov_b32 vcc_hi, 0x3000000
    v_cndmask_b32 v108, 0, v8, vcc
    s_mov_b32 vcc_lo, 0xc0000
    s_mov_b32 vcc_hi, 0xc000000
    v_cndmask_b32 v109, 0, v8, vcc
    s_mov_b32 vcc_lo, 0x300000
    s_mov_b32 vcc_hi, 0x30000000
    v_cndmask_b32 v110, 0, v8, vcc
    s_mov_b32 vcc_lo, 0xc00000
    s_mov_b32 vcc_hi, 0xc0000000
    v_cndmask_b32 v111, 0, v8, vcc
    v_mov_b32 v16, 0
    v_mov_b32 v17, 0
    v_mov_b32 v18, 0
    v_mov_b32 v19, 0
    v_mov_b32 v20, 0
    v_mov_b32 v21, 0
    v_mov_b32 v22, 0
    v_mov_b32 v23, 0
    v_mov_b32 v24, 0
    v_mov_b32 v25, 0
    v_mov_b32 v26, 0
    v_mov_b32 v27, 0
    v_mov_b32 v28, 0
    v_mov_b32 v29, 0
    v_mov_b32 v30, 0
    v_mov_b32 v31, 0
    v_mov_b32 v32, 0
    v_mov_b32 v33, 0
    v_mov_b32 v34, 0
    v_mov_b32 v35, 0
    v_mov_b32 v36, 0
    v_mov_b32 v37, 0
    v_mov_b32 v38, 0
    v_mov_b32 v39, 0
    v_mov_b32 v40, 0
    v_mov_b32 v41, 0
    v_mov_b32 v42, 0
    v_mov_b32 v43, 0
    v_mov_b32 v44, 0
    v_mov_b32 v45, 0
    v_mov_b32 v46, 0
    v_mov_b32 v47, 0
    v_and_b32 v8, 31, v0
    v_lshrrev_b32 v9, 5, v0
    s_cmp_eq_u32 s61, 3
    s_cbranch_scc0 L_fa_c
    s_mul_i32 s64, s76, 5
    s_sub_u32 s64, s64, 3
    s_add_u32 s65, s87, 1024
    v_lshrrev_b32 v12, 3, v8
    v_and_b32 v126, 7, v8
    v_mad_u32_u24 v126, v12, 5, v126
    v_mov_b32 v12, -8
    v_mov_b32 v13, s65
    s_mov_b32 exec_lo, 0xff
    s_mov_b32 exec_hi, 0xff
    v_mov_b32 v12, s64
    v_mov_b32 v13, s87
    s_mov_b64 exec, -1
    v_add_u32 v126, v12, v126
    v_lshl_add_u32 v13, v9, 3, v13
    v_bfe_u32 v12, v126, 2, 2
    v_lshl_add_u32 v13, v12, 6, v13
    v_and_b32 v126, 3, v126
    v_mul_u32_u24 v126, 0x110, v126
    v_add_u32 v126, v126, v13
    s_branch L_fa_d
L_fa_c:
    v_and_b32 v12, 15, v8
    v_min_u32 v12, 14, v12
    v_mul_u32_u24 v11, 52, v12
    v_lshrrev_b32 v11, 8, v11
    v_lshrrev_b32 v13, 4, v8
    s_lshl_b32 s64, s62, 1
    v_add_u32 v13, s64, v13
    v_sub_u32 v10, v13, v11
    v_mad_u32_u24 v10, v10, 5, v12
    v_and_b32 v10, 63, v10
    v_add_u32 v11, 1, v11
    v_and_b32 v10, 3, v12
    v_xor_b32 v126, v10, v9
    v_lshlrev_b32 v126, 4, v126
    v_lshl_add_u32 v126, v10, 8, v126
    v_lshrrev_b32 v12, 2, v12
    v_lshl_add_u32 v126, v12, 6, v126
    v_lshl_add_u32 v126, v13, 13, v126
    v_add_u32 v126, 70656, v126
L_fa_d:
    s_branch L_rpoll
L_common:
    s_mov_b64 s[70:71], 0
    s_mov_b64 s[72:73], 0
    s_mov_b64 s[96:97], 0
    s_mov_b64 s[98:99], 0
    v_and_b32 v8, 1, v0
    v_lshlrev_b32 v8, 4, v8
    v_mov_b32 v9, 0x3f80
    v_lshlrev_b32 v8, v8, v9
    s_mov_b32 vcc_lo, 0x3
    s_mov_b32 vcc_hi, 0x300
    v_cndmask_b32 v104, 0, v8, vcc
    s_mov_b32 vcc_lo, 0xc
    s_mov_b32 vcc_hi, 0xc00
    v_cndmask_b32 v105, 0, v8, vcc
    s_mov_b32 vcc_lo, 0x30
    s_mov_b32 vcc_hi, 0x3000
    v_cndmask_b32 v106, 0, v8, vcc
    s_mov_b32 vcc_lo, 0xc0
    s_mov_b32 vcc_hi, 0xc000
    v_cndmask_b32 v107, 0, v8, vcc
    s_mov_b32 vcc_lo, 0x30000
    s_mov_b32 vcc_hi, 0x3000000
    v_cndmask_b32 v108, 0, v8, vcc
    s_mov_b32 vcc_lo, 0xc0000
    s_mov_b32 vcc_hi, 0xc000000
    v_cndmask_b32 v109, 0, v8, vcc
    s_mov_b32 vcc_lo, 0x300000
    s_mov_b32 vcc_hi, 0x30000000
    v_cndmask_b32 v110, 0, v8, vcc
    s_mov_b32 vcc_lo, 0xc00000
    s_mov_b32 vcc_hi, 0xc0000000
    v_cndmask_b32 v111, 0, v8, vcc
    v_mov_b32 v16, 0
    v_mov_b32 v17, 0
    v_mov_b32 v18, 0
    v_mov_b32 v19, 0
    v_mov_b32 v20, 0
    v_mov_b32 v21, 0
    v_mov_b32 v22, 0
    v_mov_b32 v23, 0
    v_mov_b32 v24, 0
    v_mov_b32 v25, 0
    v_mov_b32 v26, 0
    v_mov_b32 v27, 0
    v_mov_b32 v28, 0
    v_mov_b32 v29, 0
    v_mov_b32 v30, 0
    v_mov_b32 v31, 0
    v_mov_b32 v32, 0
    v_mov_b32 v33, 0
    v_mov_b32 v34, 0
    v_mov_b32 v35, 0
    v_mov_b32 v36, 0
    v_mov_b32 v37, 0
    v_mov_b32 v38, 0
    v_mov_b32 v39, 0
    v_mov_b32 v40, 0
    v_mov_b32 v41, 0
    v_mov_b32 v42, 0
    v_mov_b32 v43, 0
    v_mov_b32 v44, 0
    v_mov_b32 v45, 0
    v_mov_b32 v46, 0
    v_mov_b32 v47, 0
    v_mov_b32 v112, 162544
L_sy9:
    ds_read_b32 v113, v112
    s_waitcnt lgkmcnt(0)
    v_readfirstlane_b32 s64, v113
    s_cmp_ge_u32 s64, 8
    s_cbranch_scc1 L_syd9
    s_sleep 1
    s_branch L_sy9
L_syd9:
    s_cmp_eq_u32 s60, 7
    s_cbranch_scc0 L_rlk
    v_mov_b32 v112, 162520
L_sy10:
    ds_read_b32 v113, v112
    s_waitcnt lgkmcnt(0)
    v_readfirstlane_b32 s64, v113
    s_cmp_ge_u32 s64, 8
    s_cbranch_scc1 L_syd10
    s_sleep 1
    s_branch L_sy10
L_syd10:
    v_lshlrev_b32 v15, 4, v0
    s_mov_b32 s94, 0
    s_and_b32 s66, s2, 15
    s_mul_i32 s66, s66, 1024
    s_add_u32 s66, s66, 13631488
    s_sub_u32 s93, s92, 600
    s_mov_b32 s83, 8192
    s_mov_b32 exec_lo, -1
    s_mov_b32 exec_hi, 0x1ff
    buffer_load_dwordx4 v[96:99], v15, s[40:43], s66 offen sc1
    s_mov_b64 exec, -1
L_rlk:
    v_mov_b32 v112, 162536
L_sy11:
    ds_read_b32 v113, v112
    s_waitcnt lgkmcnt(0)
    v_readfirstlane_b32 s64, v113
    s_cmp_ge_u32 s64, 8
    s_cbranch_scc1 L_syd11
    s_sleep 2
    s_branch L_sy11
L_syd11:
    v_xor_b32 v14, 32, v1
    ds_read_u16 v10, v1
    ds_read_u16 v12, v14 offset:512
    ds_read_u16 v80, v1 offset:1024
    ds_read_u16 v82, v14 offset:1536
    v_mov_b32 v11, v2
    v_mov_b32 v13, v2
    v_mov_b32 v81, v2
    v_mov_b32 v83, v2
    s_waitcnt lgkmcnt(0)
    s_cmp_eq_u32 s60, 7
    s_cbranch_scc0 L_rwait
    s_mov_b32 exec_lo, -1
    s_mov_b32 exec_hi, 0x1ff
    s_branch L_qpoll1
L_qpoll:
    s_mov_b32 exec_lo, -1
    s_mov_b32 exec_hi, 0x1ff
    buffer_load_dwordx4 v[96:99], v15, s[40:43], s66 offen sc1
L_qpoll1:
    s_add_u32 s94, s94, 1
    s_waitcnt vmcnt(0)
    v_xor_b32 v96, 1515890085, v96
    v_xor_b32 v97, 1515890085, v97
    v_xor_b32 v98, 1515890085, v98
    v_xor_b32 v99, 1515890085, v99
    v_subrev_u32 v96, s93, v96
    v_subrev_u32 v97, s93, v97
    v_subrev_u32 v98, s93, v98
    v_subrev_u32 v99, s93, v99
    v_max_u32 v96, v96, v97
    v_max3_u32 v96, v96, v98, v99
    v_cmp_le_u32 vcc, s83, v96
    s_cmp_eq_u64 vcc, 0
    s_cbranch_scc1 L_qp_ok
    s_sleep 4
    s_cmp_lt_u32 s94, 3000
    s_cbranch_scc1 L_qpoll
    v_mov_b32 v8, 162464
    v_mov_b32 v9, 2
    ds_or_b32 v8, v9
L_qp_ok:
    s_mov_b64 exec, -1
    v_mov_b32 v112, 162540
    v_mov_b32 v113, 1
    s_mov_b64 exec, 1
    ds_add_u32 v112, v113
    s_mov_b64 exec, -1
    s_branch L_rpre
L_rwait:
    v_mov_b32 v112, 162540
L_sy12:
    ds_read_b32 v113, v112
    s_waitcnt lgkmcnt(0)
    v_readfirstlane_b32 s64, v113
    s_cmp_ge_u32 s64, 1
    s_cbranch_scc1 L_syd12
    s_sleep 1
    s_branch L_sy12
L_syd12:
L_rpre:
    s_mov_b32 m0, s87
    s_nop 0
    buffer_load_dwordx4 v[10:11], s[44:47], 0 idxen offen sc1 lds
    s_add_u32 m0, s87, 1024
    s_nop 0
    buffer_load_dwordx4 v[12:13], s[44:47], 0 idxen offen sc1 lds
    s_mov_b32 s91, 1
    s_branch L_ba
    s_branch L_rpoll
L_rpoll_again:
    s_cmp_eq_u64 s[96:97], 0
    s_cbranch_scc1 L_rp_noa1
    s_mov_b64 exec, s[96:97]
    buffer_load_dwordx4 v[96:99], v120, s[40:43], s66 offen sc1
L_rp_noa1:
    s_cmp_eq_u64 s[74:75], 0
    s_cbranch_scc1 L_rp_nob1
    s_mov_b64 exec, s[74:75]
    buffer_load_dwordx4 v[100:103], v120, s[40:43], s67 offen sc1
L_rp_nob1:
    s_mov_b64 exec, -1
L_rpoll:
    s_add_u32 s94, s94, 1
    s_waitcnt vmcnt(0)
    v_bfe_u32 v10, v99, 3, 9
    v_xor_b32 v10, 421, v10
    v_lshrrev_b32 v8, 23, v96
    v_lshrrev_b32 v9, 23, v98
    v_subrev_u32 v11, s93, v99
    v_cmp_eq_u32 vcc, v8, v10
    v_cmp_eq_u32 s[70:71], v9, v10
    s_and_b64 vcc, vcc, s[70:71]
    v_cmp_gt_u32 s[70:71], s83, v11
    s_and_b64 vcc, vcc, s[70:71]
    s_andn2_b64 s[96:97], s[96:97], vcc
    v_bfe_u32 v10, v103, 3, 9
    v_xor_b32 v10, 421, v10
    v_lshrrev_b32 v8, 23, v100
    v_lshrrev_b32 v9, 23, v102
    v_subrev_u32 v11, s93, v103
    v_cmp_eq_u32 s[72:73], v8, v10
    v_cmp_eq_u32 s[70:71], v9, v10
    s_and_b64 s[72:73], s[72:73], s[70:71]
    v_cmp_gt_u32 s[70:71], s83, v11
    s_and_b64 s[72:73], s[72:73], s[70:71]
    v_bfe_u32 v8, v96, 22, 1
    s_andn2_b64 s[98:99], s[98:99], s[72:73]
    v_cmp_ne_u32 vcc, 0, v8
    s_andn2_b64 vcc, vcc, s[96:97]
    s_or_b64 vcc, vcc, s[96:97]
    s_and_b64 s[74:75], s[98:99], vcc
    s_or_b64 vcc, s[96:97], s[74:75]
    s_cmp_eq_u64 vcc, 0
    s_cbranch_scc1 L_rp_ok
    s_sleep 4
    s_cmp_lt_u32 s94, 3000
    s_cbranch_scc1 L_rpoll_again
    v_mov_b32 v8, 162464
    v_mov_b32 v9, 1
    ds_or_b32 v8, v9
    s_andn2_b64 s[68:69], s[68:69], vcc
L_rp_ok:
    s_mov_b64 exec, -1
    v_mov_b32 v112, 162520
    v_mov_b32 v113, 1
    s_mov_b64 exec, 1
    ds_add_u32 v112, v113
    s_mov_b64 exec, -1
    v_bfe_u32 v8, v96, 20, 1
    v_bfe_u32 v9, v98, 20, 1
    v_bfe_u32 v10, v100, 20, 1
    v_bfe_u32 v11, v102, 20, 1
    v_bfe_u32 v12, v96, 22, 1
    v_bfe_u32 v13, v96, 21, 2
    v_and_b32 v10, v10, v12
    v_and_b32 v11, v11, v12
    v_cmp_ne_u32 s[70:71], 0, v8
    v_cmp_ne_u32 s[72:73], 0, v9
    v_cmp_ne_u32 s[96:97], 0, v10
    v_cmp_ne_u32 s[98:99], 0, v11
    v_cmp_eq_u32 s[74:75], 3, v13
    s_and_b64 s[70:71], s[70:71], s[68:69]
    s_and_b64 s[72:73], s[72:73], s[68:69]
    s_and_b64 s[96:97], s[96:97], s[68:69]
    s_and_b64 s[98:99], s[98:99], s[68:69]
    s_and_b64 s[74:75], s[74:75], s[68:69]
    v_mov_b32 v89, 1
    s_mov_b32 s64, 162432
    v_mov_b32 v112, 162512
L_sy13:
    ds_read_b32 v113, v112
    s_waitcnt lgkmcnt(0)
    v_readfirstlane_b32 s65, v113
    s_cmp_ge_u32 s65, 8
    s_cbranch_scc1 L_syd13
    s_sleep 1
    s_branch L_sy13
L_syd13:
    s_cmp_eq_u64 s[70:71], 0
    s_cbranch_scc1 L_s1i0
    v_and_b32 v91, 0x3fff, v96
    v_mul_u32_u24 v8, 6, v91
    v_and_b32 v8, -4, v8
    s_mov_b64 exec, s[70:71]
    buffer_load_dwordx2 v[56:57], v8, s[12:15], 0 offen
    v_bfe_u32 v124, v96, 14, 6
    v_mul_u32_u24 v80, 52, v124
    v_lshrrev_b32 v80, 8, v80
    v_lshl_add_u32 v9, v80, 2, s64
    ds_add_rtn_u32 v84, v9, v89
    v_mul_u32_u24 v9, 5, v80
    v_sub_u32 v124, v124, v9
    s_mov_b64 exec, -1
    v_mul_u32_u24 v80, 8704, v80
L_s1i0:
    s_cmp_eq_u64 s[72:73], 0
    s_cbranch_scc1 L_s1i1
    v_and_b32 v92, 0x3fff, v98
    v_mul_u32_u24 v8, 6, v92
    v_and_b32 v8, -4, v8
    s_mov_b64 exec, s[72:73]
    buffer_load_dwordx2 v[58:59], v8, s[12:15], 0 offen
    v_bfe_u32 v125, v98, 14, 6
    v_mul_u32_u24 v81, 52, v125
    v_lshrrev_b32 v81, 8, v81
    v_lshl_add_u32 v9, v81, 2, s64
    ds_add_rtn_u32 v85, v9, v89
    v_mul_u32_u24 v9, 5, v81
    v_sub_u32 v125, v125, v9
    s_mov_b64 exec, -1
    v_mul_u32_u24 v81, 8704, v81
L_s1i1:
    s_cmp_eq_u64 s[96:97], 0
    s_cbranch_scc1 L_s1i2
    v_and_b32 v93, 0x3fff, v100
    v_mul_u32_u24 v8, 6, v93
    v_and_b32 v8, -4, v8
    s_mov_b64 exec, s[96:97]
    buffer_load_dwordx2 v[60:61], v8, s[12:15], 0 offen
    v_bfe_u32 v95, v100, 14, 6
    v_mul_u32_u24 v82, 52, v95
    v_lshrrev_b32 v82, 8, v82
    v_lshl_add_u32 v9, v82, 2, s64
    ds_add_rtn_u32 v86, v9, v89
    v_mul_u32_u24 v9, 5, v82
    v_sub_u32 v95, v95, v9
    s_mov_b64 exec, -1
    v_mul_u32_u24 v82, 8704, v82
L_s1i2:
    s_cmp_eq_u64 s[98:99], 0
    s_cbranch_scc1 L_s1i3
    v_and_b32 v94, 0x3fff, v102
    v_mul_u32_u24 v8, 6, v94
    v_and_b32 v8, -4, v8
    s_mov_b64 exec, s[98:99]
    buffer_load_dwordx2 v[62:63], v8, s[12:15], 0 offen
    v_bfe_u32 v88, v102, 14, 6
    v_mul_u32_u24 v83, 52, v88
    v_lshrrev_b32 v83, 8, v83
    v_lshl_add_u32 v9, v83, 2, s64
    ds_add_rtn_u32 v87, v9, v89
    v_mul_u32_u24 v9, 5, v83
    v_sub_u32 v88, v88, v9
    s_mov_b64 exec, -1
    v_mul_u32_u24 v83, 8704, v83
L_s1i3:
    s_cmp_eq_u64 s[74:75], 0
    s_cbranch_scc1 L_s1_noovf
    v_mov_b32 v8, 162464
    ds_or_b32 v8, v89
L_s1_noovf:
    s_waitcnt lgkmcnt(0)
    s_cmp_eq_u64 s[70:71], 0
    s_cbranch_scc1 L_s1p0
    v_cmp_gt_u32 vcc, 136, v84
    v_lshl_add_u32 v80, v84, 6, v80
    v_bfe_u32 v84, v84, 2, 2
    v_lshl_add_u32 v80, v84, 4, v80
    v_xor_b32 v84, 16, v80
    s_andn2_b64 exec, s[70:71], vcc
    s_cbranch_execz L_s1_oka
    v_mov_b32 v8, 162464
    ds_or_b32 v8, v89
L_s1_oka:
    s_and_b64 s[70:71], s[70:71], vcc
    s_mov_b64 exec, s[70:71]
    ds_write_b16 v84, v91 offset:0
    s_mov_b64 exec, -1
L_s1p0:
    s_cmp_eq_u64 s[72:73], 0
    s_cbranch_scc1 L_s1p1
    v_cmp_gt_u32 vcc, 136, v85
    v_lshl_add_u32 v81, v85, 6, v81
    v_bfe_u32 v85, v85, 2, 2
    v_lshl_add_u32 v81, v85, 4, v81
    v_xor_b32 v85, 16, v81
    s_andn2_b64 exec, s[72:73], vcc
    s_cbranch_execz L_s1_okb
    v_mov_b32 v8, 162464
    ds_or_b32 v8, v89
L_s1_okb:
    s_and_b64 s[72:73], s[72:73], vcc
    s_mov_b64 exec, s[72:73]
    ds_write_b16 v85, v92 offset:0
    s_mov_b64 exec, -1
L_s1p1:
    s_cmp_eq_u64 s[96:97], 0
    s_cbranch_scc1 L_s1p2
    v_cmp_gt_u32 vcc, 136, v86
    v_lshl_add_u32 v82, v86, 6, v82
    v_bfe_u32 v86, v86, 2, 2
    v_lshl_add_u32 v82, v86, 4, v82
    v_xor_b32 v86, 16, v82
    s_andn2_b64 exec, s[96:97], vcc
    s_cbranch_execz L_s1_okc
    v_mov_b32 v8, 162464
    ds_or_b32 v8, v89
L_s1_okc:
    s_and_b64 s[96:97], s[96:97], vcc
    s_mov_b64 exec, s[96:97]
    ds_write_b16 v86, v93 offset:0
    s_mov_b64 exec, -1
L_s1p2:
    s_cmp_eq_u64 s[98:99], 0
    s_cbranch_scc1 L_s1p3
    v_cmp_gt_u32 vcc, 136, v87
    v_lshl_add_u32 v83, v87, 6, v83
    v_bfe_u32 v87, v87, 2, 2
    v_lshl_add_u32 v83, v87, 4, v83
    v_xor_b32 v87, 16, v83
    s_andn2_b64 exec, s[98:99], vcc
    s_cbranch_execz L_s1_okd
    v_mov_b32 v8, 162464
    ds_or_b32 v8, v89
L_s1_okd:
    s_and_b64 s[98:99], s[98:99], vcc
    s_mov_b64 exec, s[98:99]
    ds_write_b16 v87, v94 offset:0
    s_mov_b64 exec, -1
L_s1p3:
    v_mov_b32 v112, 162536
    v_mov_b32 v113, 1
    s_mov_b64 exec, 1
    ds_add_u32 v112, v113
    s_mov_b64 exec, -1
L_st2:
    s_mov_b32 s64, 161792
    s_mov_b32 s82, 0xffff0000
    v_mov_b32 v14, 0x3c00
    s_cmp_eq_u64 s[70:71], 0
    s_cbranch_scc1 L_s2r0
    v_bfe_u32 v13, v96, 14, 6
    v_min_u32 v13, 39, v13
    v_lshl_add_u32 v13, v13, 4, s64
    ds_read_b128 v[48:51], v13
L_s2r0:
    s_cmp_eq_u64 s[72:73], 0
    s_cbranch_scc1 L_s2r1
    v_bfe_u32 v13, v98, 14, 6
    v_min_u32 v13, 39, v13
    v_lshl_add_u32 v13, v13, 4, s64
    ds_read_b128 v[52:55], v13
L_s2r1:
    s_cmp_eq_u64 s[96:97], 0
    s_cbranch_scc1 L_s2r2
    v_bfe_u32 v13, v100, 14, 6
    v_min_u32 v13, 39, v13
    v_lshl_add_u32 v13, v13, 4, s64
    ds_read_b128 v[112:115], v13
L_s2r2:
    s_cmp_eq_u64 s[98:99], 0
    s_cbranch_scc1 L_s2r3
    v_bfe_u32 v13, v102, 14, 6
    v_min_u32 v13, 39, v13
    v_lshl_add_u32 v13, v13, 4, s64
    ds_read_b128 v[116:119], v13
L_s2r3:
    s_waitcnt vmcnt(0) lgkmcnt(0)
    s_cmp_eq_u64 s[70:71], 0
    s_cbranch_scc1 L_s2_donea
    s_mov_b64 exec, s[70:71]
    v_and_b32 v84, 1, v96
    v_lshlrev_b32 v84, 4, v84
    v_alignbit_b32 v85, v57, v56, v84
    v_lshrrev_b32 v86, v84, v57
    v_lshlrev_b32 v56, 16, v85
    v_and_b32 v57, s82, v85
    v_lshlrev_b32 v86, 16, v86
    v_sub_f32 v48, v48, v56
    v_sub_f32 v49, v49, v57
    v_sub_f32 v50, v50, v86
    v_cvt_pk_bf16_f32 v84, v48, v49
    v_cvt_pk_bf16_f32 v85, v50, v50
    v_lshlrev_b32 v48, 16, v84
    v_and_b32 v49, s82, v84
    v_lshlrev_b32 v50, 16, v85
    v_lshl_add_u32 v87, v124, 1, v80
    v_xor_b32 v92, 16, v87
    v_cvt_pk_f16_f32 v84, v48, v49
    v_cvt_pk_f16_f32 v85, v50, v50
    ds_write_b16 v87, v14 offset:6
    ds_write_b16 v92, v84 offset:6
    v_xor_b32 v92, 32, v87
    v_xor_b32 v87, 48, v87
    ds_write_b16_d16_hi v92, v84 offset:6
    ds_write_b16 v87, v85 offset:6
    v_mul_f32 v48, v48, v48
    v_mul_f32 v49, v49, v49
    v_mul_f32 v50, v50, v50
    v_cvt_pk_bf16_f32 v86, v48, v49
    v_cvt_pk_bf16_f32 v91, v50, v50
    v_lshlrev_b32 v48, 16, v86
    v_and_b32 v49, s82, v86
    v_lshlrev_b32 v50, 16, v91
    v_add_f32 v48, v48, v49
    v_add_f32 v48, v48, v50
    v_cvt_pk_bf16_f32 v86, v48, 0
    v_lshl_or_b32 v91, v97, 16, v86
    ds_write_b32 v80, v91 offset:0
    ds_write_b16 v80, v86 offset:4
    s_mov_b64 exec, -1
L_s2_donea:
    s_cmp_eq_u64 s[72:73], 0
    s_cbranch_scc1 L_s2_doneb
    s_mov_b64 exec, s[72:73]
    v_and_b32 v84, 1, v98
    v_lshlrev_b32 v84, 4, v84
    v_alignbit_b32 v85, v59, v58, v84
    v_lshrrev_b32 v86, v84, v59
    v_lshlrev_b32 v58, 16, v85
    v_and_b32 v59, s82, v85
    v_lshlrev_b32 v86, 16, v86
    v_sub_f32 v52, v52, v58
    v_sub_f32 v53, v53, v59
    v_sub_f32 v54, v54, v86
    v_cvt_pk_bf16_f32 v84, v52, v53
    v_cvt_pk_bf16_f32 v85, v54, v54
    v_lshlrev_b32 v52, 16, v84
    v_and_b32 v53, s82, v84
    v_lshlrev_b32 v54, 16, v85
    v_lshl_add_u32 v87, v125, 1, v81
    v_xor_b32 v92, 16, v87
    v_cvt_pk_f16_f32 v84, v52, v53
    v_cvt_pk_f16_f32 v85, v54, v54
    ds_write_b16 v87, v14 offset:6
    ds_write_b16 v92, v84 offset:6
    v_xor_b32 v92, 32, v87
    v_xor_b32 v87, 48, v87
    ds_write_b16_d16_hi v92, v84 offset:6
    ds_write_b16 v87, v85 offset:6
    v_mul_f32 v52, v52, v52
    v_mul_f32 v53, v53, v53
    v_mul_f32 v54, v54, v54
    v_cvt_pk_bf16_f32 v86, v52, v53
    v_cvt_pk_bf16_f32 v91, v54, v54
    v_lshlrev_b32 v52, 16, v86
    v_and_b32 v53, s82, v86
    v_lshlrev_b32 v54, 16, v91
    v_add_f32 v52, v52, v53
    v_add_f32 v52, v52, v54
    v_cvt_pk_bf16_f32 v86, v52, 0
    v_and_or_b32 v91, v97, s82, v86
    ds_write_b32 v81, v91 offset:0
    ds_write_b16 v81, v86 offset:4
    s_mov_b64 exec, -1
L_s2_doneb:
    s_cmp_eq_u64 s[96:97], 0
    s_cbranch_scc1 L_s2_donec
    s_mov_b64 exec, s[96:97]
    v_and_b32 v84, 1, v100
    v_lshlrev_b32 v84, 4, v84
    v_alignbit_b32 v85, v61, v60, v84
    v_lshrrev_b32 v86, v84, v61
    v_lshlrev_b32 v60, 16, v85
    v_and_b32 v61, s82, v85
    v_lshlrev_b32 v86, 16, v86
    v_sub_f32 v112, v112, v60
    v_sub_f32 v113, v113, v61
    v_sub_f32 v114, v114, v86
    v_cvt_pk_bf16_f32 v84, v112, v113
    v_cvt_pk_bf16_f32 v85, v114, v114
    v_lshlrev_b32 v112, 16, v84
    v_and_b32 v113, s82, v84
    v_lshlrev_b32 v114, 16, v85
    v_lshl_add_u32 v87, v95, 1, v82
    v_xor_b32 v92, 16, v87
    v_cvt_pk_f16_f32 v84, v112, v113
    v_cvt_pk_f16_f32 v85, v114, v114
    ds_write_b16 v87, v14 offset:6
    ds_write_b16 v92, v84 offset:6
    v_xor_b32 v92, 32, v87
    v_xor_b32 v87, 48, v87
    ds_write_b16_d16_hi v92, v84 offset:6
    ds_write_b16 v87, v85 offset:6
    v_mul_f32 v112, v112, v112
    v_mul_f32 v113, v113, v113
    v_mul_f32 v114, v114, v114
    v_cvt_pk_bf16_f32 v86, v112, v113
    v_cvt_pk_bf16_f32 v91, v114, v114
    v_lshlrev_b32 v112, 16, v86
    v_and_b32 v113, s82, v86
    v_lshlrev_b32 v114, 16, v91
    v_add_f32 v112, v112, v113
    v_add_f32 v112, v112, v114
    v_cvt_pk_bf16_f32 v86, v112, 0
    v_lshl_or_b32 v91, v101, 16, v86
    ds_write_b32 v82, v91 offset:0
    ds_write_b16 v82, v86 offset:4
    s_mov_b64 exec, -1
L_s2_donec:
    s_cmp_eq_u64 s[98:99], 0
    s_cbranch_scc1 L_s2_doned
    s_mov_b64 exec, s[98:99]
    v_and_b32 v84, 1, v102
    v_lshlrev_b32 v84, 4, v84
    v_alignbit_b32 v85, v63, v62, v84
    v_lshrrev_b32 v86, v84, v63
    v_lshlrev_b32 v62, 16, v85
    v_and_b32 v63, s82, v85
    v_lshlrev_b32 v86, 16, v86
    v_sub_f32 v116, v116, v62
    v_sub_f32 v117, v117, v63
    v_sub_f32 v118, v118, v86
    v_cvt_pk_bf16_f32 v84, v116, v117
    v_cvt_pk_bf16_f32 v85, v118, v118
    v_lshlrev_b32 v116, 16, v84
    v_and_b32 v117, s82, v84
    v_lshlrev_b32 v118, 16, v85
    v_lshl_add_u32 v87, v88, 1, v83
    v_xor_b32 v92, 16, v87
    v_cvt_pk_f16_f32 v84, v116, v117
    v_cvt_pk_f16_f32 v85, v118, v118
    ds_write_b16 v87, v14 offset:6
    ds_write_b16 v92, v84 offset:6
    v_xor_b32 v92, 32, v87
    v_xor_b32 v87, 48, v87
    ds_write_b16_d16_hi v92, v84 offset:6
    ds_write_b16 v87, v85 offset:6
    v_mul_f32 v116, v116, v116
    v_mul_f32 v117, v117, v117
    v_mul_f32 v118, v118, v118
    v_cvt_pk_bf16_f32 v86, v116, v117
    v_cvt_pk_bf16_f32 v91, v118, v118
    v_lshlrev_b32 v116, 16, v86
    v_and_b32 v117, s82, v86
    v_lshlrev_b32 v118, 16, v91
    v_add_f32 v116, v116, v117
    v_add_f32 v116, v116, v118
    v_cvt_pk_bf16_f32 v86, v116, 0
    v_and_or_b32 v91, v101, s82, v86
    ds_write_b32 v83, v91 offset:0
    ds_write_b16 v83, v86 offset:4
    s_mov_b64 exec, -1
L_s2_doned:
L_ba:
    s_setprio 3
    s_waitcnt lgkmcnt(0)
    s_barrier
L_post:
    s_lshl_b32 s64, s76, 2
    s_add_u32 s64, s64, 162432
    v_mov_b32 v8, s64
    v_mov_b32 v9, 162464
    s_cmp_eq_u32 s63, 0
    s_cbranch_scc0 L_post_slow
    s_cmp_eq_u32 s91, 0
    s_cbranch_scc1 L_post_g
    ds_read_b32 v8, v8
    ds_read_b32 v9, v9
    s_mov_b32 m0, s88
    s_nop 0
    buffer_load_dwordx4 v[80:81], s[44:47], 0 idxen offen sc1 lds
    s_add_u32 m0, s88, 1024
    s_nop 0
    buffer_load_dwordx4 v[82:83], s[44:47], 0 idxen offen sc1 lds
    s_branch L_post_fast
L_post_g:
    v_xor_b32 v14, 32, v1
    ds_read_u16 v10, v1
    ds_read_u16 v12, v14 offset:512
    ds_read_u16 v80, v1 offset:1024
    ds_read_u16 v82, v14 offset:1536
    ds_read_b32 v8, v8
    ds_read_b32 v9, v9
    v_mov_b32 v11, v2
    v_mov_b32 v13, v2
    v_mov_b32 v81, v2
    v_mov_b32 v83, v2
    s_waitcnt lgkmcnt(4)
    s_mov_b32 m0, s87
    s_nop 0
    buffer_load_dwordx4 v[10:11], s[44:47], 0 idxen offen sc1 lds
    s_add_u32 m0, s87, 1024
    s_nop 0
    buffer_load_dwordx4 v[12:13], s[44:47], 0 idxen offen sc1 lds
    s_waitcnt lgkmcnt(2)
    s_mov_b32 m0, s88
    s_nop 0
    buffer_load_dwordx4 v[80:81], s[44:47], 0 idxen offen sc1 lds
    s_add_u32 m0, s88, 1024
    s_nop 0
    buffer_load_dwordx4 v[82:83], s[44:47], 0 idxen offen sc1 lds
    s_branch L_post_fast
L_post_slow:
    ds_read_b32 v8, v8
    ds_read_b32 v9, v9
    v_mov_b32 v15, 162432
    ds_read_b128 v[96:99], v15
    ds_read_b128 v[100:103], v15 offset:16
    s_waitcnt lgkmcnt(0)
    v_or3_b32 v96, v96, v97, v98
    v_or3_b32 v96, v96, v99, v100
    v_or3_b32 v96, v96, v101, v102
    v_or_b32 v96, v96, v103
    s_nop 0
    v_readfirstlane_b32 s64, v96
    v_readfirstlane_b32 s78, v8
    s_nop 3
    s_cmp_lg_u32 s64, 0
    s_cbranch_scc1 L_post_sg
    s_mov_b32 s86, 0
    s_branch L_slow_adv
L_post_sg:
    v_xor_b32 v14, 32, v1
    ds_read_u16 v10, v1
    ds_read_u16 v12, v14 offset:512
    ds_read_u16 v80, v1 offset:1024
    ds_read_u16 v82, v14 offset:1536
    v_mov_b32 v11, v2
    v_mov_b32 v13, v2
    v_mov_b32 v81, v2
    v_mov_b32 v83, v2
    s_waitcnt lgkmcnt(2)
    s_mov_b32 m0, s87
    s_nop 0
    buffer_load_dwordx4 v[10:11], s[44:47], 0 idxen offen sc1 lds
    s_add_u32 m0, s87, 1024
    s_nop 0
    buffer_load_dwordx4 v[12:13], s[44:47], 0 idxen offen sc1 lds
    s_waitcnt lgkmcnt(0)
    s_mov_b32 m0, s88
    s_nop 0
    buffer_load_dwordx4 v[80:81], s[44:47], 0 idxen offen sc1 lds
    s_add_u32 m0, s88, 1024
    s_nop 0
    buffer_load_dwordx4 v[82:83], s[44:47], 0 idxen offen sc1 lds
    s_branch L_post_go
L_post_fast:
    s_waitcnt lgkmcnt(0)
    v_readfirstlane_b32 s78, v8
    v_readfirstlane_b32 s67, v9
    s_nop 3
    s_cmp_lg_u32 s67, 0
    s_cbranch_scc1 L_slow_init
L_post_go:
    s_min_u32 s78, s78, 136
    s_add_u32 s79, s78, 15
    s_lshr_b32 s79, s79, 4
    s_cmp_eq_u32 s63, 0
    s_cbranch_scc1 L_noseg0
    v_and_b32 v8, 1, v0
    v_lshlrev_b32 v8, 4, v8
    v_mov_b32 v9, 0x3f80
    v_lshlrev_b32 v8, v8, v9
    s_mov_b32 vcc_lo, 0x3
    s_mov_b32 vcc_hi, 0x300
    v_cndmask_b32 v104, 0, v8, vcc
    s_mov_b32 vcc_lo, 0xc
    s_mov_b32 vcc_hi, 0xc00
    v_cndmask_b32 v105, 0, v8, vcc
    s_mov_b32 vcc_lo, 0x30
    s_mov_b32 vcc_hi, 0x3000
    v_cndmask_b32 v106, 0, v8, vcc
    s_mov_b32 vcc_lo, 0xc0
    s_mov_b32 vcc_hi, 0xc000
    v_cndmask_b32 v107, 0, v8, vcc
    s_mov_b32 vcc_lo, 0x30000
    s_mov_b32 vcc_hi, 0x3000000
    v_cndmask_b32 v108, 0, v8, vcc
    s_mov_b32 vcc_lo, 0xc0000
    s_mov_b32 vcc_hi, 0xc000000
    v_cndmask_b32 v109, 0, v8, vcc
    s_mov_b32 vcc_lo, 0x300000
    s_mov_b32 vcc_hi, 0x30000000
    v_cndmask_b32 v110, 0, v8, vcc
    s_mov_b32 vcc_lo, 0xc00000
    s_mov_b32 vcc_hi, 0xc0000000
    v_cndmask_b32 v111, 0, v8, vcc
    s_cmp_eq_u32 s84, 0
    s_cbranch_scc1 L_noseg0
    s_mov_b32 s84, 0
    v_mov_b32 v16, 0
    v_mov_b32 v17, 0
    v_mov_b32 v18, 0
    v_mov_b32 v19, 0
    v_mov_b32 v20, 0
    v_mov_b32 v21, 0
    v_mov_b32 v22, 0
    v_mov_b32 v23, 0
    v_mov_b32 v24, 0
    v_mov_b32 v25, 0
    v_mov_b32 v26, 0
    v_mov_b32 v27, 0
    v_mov_b32 v28, 0
    v_mov_b32 v29, 0
    v_mov_b32 v30, 0
    v_mov_b32 v31, 0
    v_mov_b32 v32, 0
    v_mov_b32 v33, 0
    v_mov_b32 v34, 0
    v_mov_b32 v35, 0
    v_mov_b32 v36, 0
    v_mov_b32 v37, 0
    v_mov_b32 v38, 0
    v_mov_b32 v39, 0
    v_mov_b32 v40, 0
    v_mov_b32 v41, 0
    v_mov_b32 v42, 0
    v_mov_b32 v43, 0
    v_mov_b32 v44, 0
    v_mov_b32 v45, 0
    v_mov_b32 v46, 0
    v_mov_b32 v47, 0
L_noseg0:
    s_lshl_b32 s64, s76, 11
    s_lshl_b32 s65, s77, 10
    s_add_u32 s64, s64, s65
    s_add_u32 s64, s64, 135168
    v_lshlrev_b32 v8, 4, v0
    v_add_u32 v8, s64, v8
    ds_read_b128 v[100:103], v8
    s_setprio 3
    s_mov_b32 s80, 0
    s_mov_b32 s6, 1.0
    s_mov_b32 s7, 1.0
    s_mov_b32 s81, s78
    s_mov_b32 s90, s79
    v_add_u32 v92, 2048, v1
    v_add_u32 v14, 2048, v14
    v_mov_b32 v93, v6
    v_mov_b32 v94, v5
    v_xor_b32 v95, 32, v5
    s_cmp_eq_u32 s90, 0
    s_cbranch_scc1 L_tiles_done
L_tile_loop:
    s_cmp_gt_u32 s90, 2
    s_cselect_b32 s83, 1, 0
    s_cbranch_scc0 L_nolkt0
    ds_read_u16 v10, v92 offset:0
    ds_read_u16 v12, v14 offset:512
L_nolkt0:
    ds_read_b128 v[96:99], v93 offset:0
    s_cmp_gt_u32 s90, 1
    s_cbranch_scc1 L_w2t0
    s_waitcnt vmcnt(0)
    s_branch L_wdt0
L_w2t0:
    s_waitcnt vmcnt(2)
L_wdt0:
    ds_read_b64_tr_b16 v[80:81], v3 offset:0
    ds_read_b64_tr_b16 v[82:83], v3 offset:512
    ds_read_b64_tr_b16 v[84:85], v4 offset:0
    ds_read_b64_tr_b16 v[86:87], v4 offset:512
    ds_read_b64_tr_b16 v[88:89], v94 offset:0
    ds_read_b64_tr_b16 v[90:91], v95 offset:512
    s_waitcnt lgkmcnt(6)
    v_mfma_f32_32x32x16_bf16 v[48:63], v[96:99], v[100:103], 0
    s_waitcnt lgkmcnt(4)
    v_mfma_f32_32x32x16_bf16 v[48:63], v[104:107], v[80:83], v[48:63]
    s_waitcnt lgkmcnt(2)
    v_mfma_f32_32x32x16_bf16 v[48:63], v[108:111], v[84:87], v[48:63]
    s_cmp_eq_u32 s83, 0
    s_cbranch_scc1 L_nodmat0
    s_mov_b32 m0, s87
    s_nop 0
    buffer_load_dwordx4 v[10:11], s[44:47], 0 idxen offen sc1 lds
    s_add_u32 m0, s87, 1024
    s_nop 0
    buffer_load_dwordx4 v[12:13], s[44:47], 0 idxen offen sc1 lds
L_nodmat0:
    s_nop 7
    s_nop 3
    v_cvt_pk_f16_f32 v112, v48, v49
    v_cvt_pk_f16_f32 v113, v50, v51
    v_cvt_pk_f16_f32 v116, v56, v57
    v_cvt_pk_f16_f32 v117, v58, v59
    v_exp_f16_sdwa v80, v112 dst_sel:WORD_0 dst_unused:UNUSED_PAD src0_sel:WORD_0
    v_exp_f16_sdwa v81, v113 dst_sel:WORD_0 dst_unused:UNUSED_PAD src0_sel:WORD_0
    v_exp_f16_sdwa v82, v116 dst_sel:WORD_0 dst_unused:UNUSED_PAD src0_sel:WORD_0
    v_exp_f16_sdwa v83, v117 dst_sel:WORD_0 dst_unused:UNUSED_PAD src0_sel:WORD_0
    v_exp_f16_sdwa v80, v112 dst_sel:WORD_1 dst_unused:UNUSED_PRESERVE src0_sel:WORD_1
    v_exp_f16_sdwa v81, v113 dst_sel:WORD_1 dst_unused:UNUSED_PRESERVE src0_sel:WORD_1
    v_exp_f16_sdwa v82, v116 dst_sel:WORD_1 dst_unused:UNUSED_PRESERVE src0_sel:WORD_1
    v_exp_f16_sdwa v83, v117 dst_sel:WORD_1 dst_unused:UNUSED_PRESERVE src0_sel:WORD_1
    v_pk_add_f16 v80, v80, 1.0 op_sel_hi:[1,0]
    v_pk_add_f16 v81, v81, 1.0 op_sel_hi:[1,0]
    v_pk_add_f16 v82, v82, 1.0 op_sel_hi:[1,0]
    v_pk_add_f16 v83, v83, 1.0 op_sel_hi:[1,0]
    v_rcp_f16_sdwa v80, v80 dst_sel:WORD_0 dst_unused:UNUSED_PRESERVE src0_sel:WORD_0
    v_rcp_f16_sdwa v81, v81 dst_sel:WORD_0 dst_unused:UNUSED_PRESERVE src0_sel:WORD_0
    v_rcp_f16_sdwa v82, v82 dst_sel:WORD_0 dst_unused:UNUSED_PRESERVE src0_sel:WORD_0
    v_rcp_f16_sdwa v83, v83 dst_sel:WORD_0 dst_unused:UNUSED_PRESERVE src0_sel:WORD_0
    v_rcp_f16_sdwa v80, v80 dst_sel:WORD_1 dst_unused:UNUSED_PRESERVE src0_sel:WORD_1
    v_rcp_f16_sdwa v81, v81 dst_sel:WORD_1 dst_unused:UNUSED_PRESERVE src0_sel:WORD_1
    v_rcp_f16_sdwa v82, v82 dst_sel:WORD_1 dst_unused:UNUSED_PRESERVE src0_sel:WORD_1
    v_rcp_f16_sdwa v83, v83 dst_sel:WORD_1 dst_unused:UNUSED_PRESERVE src0_sel:WORD_1
    v_pk_mul_f16 v112, v112, v80
    v_pk_mul_f16 v113, v113, v81
    v_pk_mul_f16 v116, v116, v82
    v_pk_mul_f16 v117, v117, v83
    s_cmp_le_u32 s81, 8
    s_cbranch_scc1 L_skipt0
    v_cvt_pk_f16_f32 v114, v52, v53
    v_cvt_pk_f16_f32 v115, v54, v55
    v_cvt_pk_f16_f32 v118, v60, v61
    v_cvt_pk_f16_f32 v119, v62, v63
    v_exp_f16_sdwa v80, v114 dst_sel:WORD_0 dst_unused:UNUSED_PAD src0_sel:WORD_0
    v_exp_f16_sdwa v81, v115 dst_sel:WORD_0 dst_unused:UNUSED_PAD src0_sel:WORD_0
    v_exp_f16_sdwa v82, v118 dst_sel:WORD_0 dst_unused:UNUSED_PAD src0_sel:WORD_0
    v_exp_f16_sdwa v83, v119 dst_sel:WORD_0 dst_unused:UNUSED_PAD src0_sel:WORD_0
    v_exp_f16_sdwa v80, v114 dst_sel:WORD_1 dst_unused:UNUSED_PRESERVE src0_sel:WORD_1
    v_exp_f16_sdwa v81, v115 dst_sel:WORD_1 dst_unused:UNUSED_PRESERVE src0_sel:WORD_1
    v_exp_f16_sdwa v82, v118 dst_sel:WORD_1 dst_unused:UNUSED_PRESERVE src0_sel:WORD_1
    v_exp_f16_sdwa v83, v119 dst_sel:WORD_1 dst_unused:UNUSED_PRESERVE src0_sel:WORD_1
    v_pk_add_f16 v80, v80, 1.0 op_sel_hi:[1,0]
    v_pk_add_f16 v81, v81, 1.0 op_sel_hi:[1,0]
    v_pk_add_f16 v82, v82, 1.0 op_sel_hi:[1,0]
    v_pk_add_f16 v83, v83, 1.0 op_sel_hi:[1,0]
    v_rcp_f16_sdwa v80, v80 dst_sel:WORD_0 dst_unused:UNUSED_PRESERVE src0_sel:WORD_0
    v_rcp_f16_sdwa v81, v81 dst_sel:WORD_0 dst_unused:UNUSED_PRESERVE src0_sel:WORD_0
    v_rcp_f16_sdwa v82, v82 dst_sel:WORD_0 dst_unused:UNUSED_PRESERVE src0_sel:WORD_0
    v_rcp_f16_sdwa v83, v83 dst_sel:WORD_0 dst_unused:UNUSED_PRESERVE src0_sel:WORD_0
    v_rcp_f16_sdwa v80, v80 dst_sel:WORD_1 dst_unused:UNUSED_PRESERVE src0_sel:WORD_1
    v_rcp_f16_sdwa v81, v81 dst_sel:WORD_1 dst_unused:UNUSED_PRESERVE src0_sel:WORD_1
    v_rcp_f16_sdwa v82, v82 dst_sel:WORD_1 dst_unused:UNUSED_PRESERVE src0_sel:WORD_1
    v_rcp_f16_sdwa v83, v83 dst_sel:WORD_1 dst_unused:UNUSED_PRESERVE src0_sel:WORD_1
    v_pk_mul_f16 v114, v114, v80
    v_pk_mul_f16 v115, v115, v81
    v_pk_mul_f16 v118, v118, v82
    v_pk_mul_f16 v119, v119, v83
    s_branch L_blkt0
L_skipt0:
    v_mov_b32 v114, 0
    v_mov_b32 v115, 0
    v_mov_b32 v118, 0
    v_mov_b32 v119, 0
L_blkt0:
    s_waitcnt lgkmcnt(0)
    s_nop 1
    v_mfma_f32_32x32x16_f16 v[16:31], v[112:115], v[88:91], v[16:31]
    v_mfma_f32_32x32x16_f16 v[32:47], v[116:119], v[88:91], v[32:47]
    s_sub_u32 s81, s81, 16
    s_sub_u32 s90, s90, 1
    s_cmp_gt_u32 s90, 3
    s_cbranch_scc1 L_prt0
    s_setprio 2
    s_cmp_eq_u32 s90, 3
    s_cbranch_scc1 L_prt0
    s_setprio 1
    s_cmp_eq_u32 s90, 2
    s_cbranch_scc1 L_prt0
    s_setprio 0
L_prt0:
    s_cmp_eq_u32 s90, 0
    s_cbranch_scc1 L_tiles_done
    s_cmp_gt_u32 s90, 2
    s_cselect_b32 s83, 1, 0
    s_cbranch_scc0 L_nolkt1
    ds_read_u16 v10, v92 offset:1024
    ds_read_u16 v12, v14 offset:1536
L_nolkt1:
    ds_read_b128 v[96:99], v93 offset:1024
    s_cmp_gt_u32 s90, 1
    s_cbranch_scc1 L_w2t1
    s_waitcnt vmcnt(0)
    s_branch L_wdt1
L_w2t1:
    s_waitcnt vmcnt(2)
L_wdt1:
    ds_read_b64_tr_b16 v[80:81], v3 offset:2048
    ds_read_b64_tr_b16 v[82:83], v3 offset:2560
    ds_read_b64_tr_b16 v[84:85], v4 offset:2048
    ds_read_b64_tr_b16 v[86:87], v4 offset:2560
    ds_read_b64_tr_b16 v[88:89], v94 offset:1024
    ds_read_b64_tr_b16 v[90:91], v95 offset:1536
    v_add_u32 v92, 2048, v92
    v_add_u32 v14, 2048, v14
    v_add_u32 v93, v7, v93
    v_add_u32 v94, 2048, v94
    v_add_u32 v95, 2048, v95
    s_waitcnt lgkmcnt(6)
    v_mfma_f32_32x32x16_bf16 v[48:63], v[96:99], v[100:103], 0
    s_waitcnt lgkmcnt(4)
    v_mfma_f32_32x32x16_bf16 v[48:63], v[104:107], v[80:83], v[48:63]
    s_waitcnt lgkmcnt(2)
    v_mfma_f32_32x32x16_bf16 v[48:63], v[108:111], v[84:87], v[48:63]
    s_cmp_eq_u32 s83, 0
    s_cbranch_scc1 L_nodmat1
    s_mov_b32 m0, s88
    s_nop 0
    buffer_load_dwordx4 v[10:11], s[44:47], 0 idxen offen sc1 lds
    s_add_u32 m0, s88, 1024
    s_nop 0
    buffer_load_dwordx4 v[12:13], s[44:47], 0 idxen offen sc1 lds
L_nodmat1:
    s_nop 7
    s_nop 3
    v_cvt_pk_f16_f32 v112, v48, v49
    v_cvt_pk_f16_f32 v113, v50, v51
    v_cvt_pk_f16_f32 v116, v56, v57
    v_cvt_pk_f16_f32 v117, v58, v59
    v_exp_f16_sdwa v80, v112 dst_sel:WORD_0 dst_unused:UNUSED_PAD src0_sel:WORD_0
    v_exp_f16_sdwa v81, v113 dst_sel:WORD_0 dst_unused:UNUSED_PAD src0_sel:WORD_0
    v_exp_f16_sdwa v82, v116 dst_sel:WORD_0 dst_unused:UNUSED_PAD src0_sel:WORD_0
    v_exp_f16_sdwa v83, v117 dst_sel:WORD_0 dst_unused:UNUSED_PAD src0_sel:WORD_0
    v_exp_f16_sdwa v80, v112 dst_sel:WORD_1 dst_unused:UNUSED_PRESERVE src0_sel:WORD_1
    v_exp_f16_sdwa v81, v113 dst_sel:WORD_1 dst_unused:UNUSED_PRESERVE src0_sel:WORD_1
    v_exp_f16_sdwa v82, v116 dst_sel:WORD_1 dst_unused:UNUSED_PRESERVE src0_sel:WORD_1
    v_exp_f16_sdwa v83, v117 dst_sel:WORD_1 dst_unused:UNUSED_PRESERVE src0_sel:WORD_1
    v_pk_add_f16 v80, v80, 1.0 op_sel_hi:[1,0]
    v_pk_add_f16 v81, v81, 1.0 op_sel_hi:[1,0]
    v_pk_add_f16 v82, v82, 1.0 op_sel_hi:[1,0]
    v_pk_add_f16 v83, v83, 1.0 op_sel_hi:[1,0]
    v_rcp_f16_sdwa v80, v80 dst_sel:WORD_0 dst_unused:UNUSED_PRESERVE src0_sel:WORD_0
    v_rcp_f16_sdwa v81, v81 dst_sel:WORD_0 dst_unused:UNUSED_PRESERVE src0_sel:WORD_0
    v_rcp_f16_sdwa v82, v82 dst_sel:WORD_0 dst_unused:UNUSED_PRESERVE src0_sel:WORD_0
    v_rcp_f16_sdwa v83, v83 dst_sel:WORD_0 dst_unused:UNUSED_PRESERVE src0_sel:WORD_0
    v_rcp_f16_sdwa v80, v80 dst_sel:WORD_1 dst_unused:UNUSED_PRESERVE src0_sel:WORD_1
    v_rcp_f16_sdwa v81, v81 dst_sel:WORD_1 dst_unused:UNUSED_PRESERVE src0_sel:WORD_1
    v_rcp_f16_sdwa v82, v82 dst_sel:WORD_1 dst_unused:UNUSED_PRESERVE src0_sel:WORD_1
    v_rcp_f16_sdwa v83, v83 dst_sel:WORD_1 dst_unused:UNUSED_PRESERVE src0_sel:WORD_1
    v_pk_mul_f16 v112, v112, v80
    v_pk_mul_f16 v113, v113, v81
    v_pk_mul_f16 v116, v116, v82
    v_pk_mul_f16 v117, v117, v83
    s_cmp_le_u32 s81, 8
    s_cbranch_scc1 L_skipt1
    v_cvt_pk_f16_f32 v114, v52, v53
    v_cvt_pk_f16_f32 v115, v54, v55
    v_cvt_pk_f16_f32 v118, v60, v61
    v_cvt_pk_f16_f32 v119, v62, v63
    v_exp_f16_sdwa v80, v114 dst_sel:WORD_0 dst_unused:UNUSED_PAD src0_sel:WORD_0
    v_exp_f16_sdwa v81, v115 dst_sel:WORD_0 dst_unused:UNUSED_PAD src0_sel:WORD_0
    v_exp_f16_sdwa v82, v118 dst_sel:WORD_0 dst_unused:UNUSED_PAD src0_sel:WORD_0
    v_exp_f16_sdwa v83, v119 dst_sel:WORD_0 dst_unused:UNUSED_PAD src0_sel:WORD_0
    v_exp_f16_sdwa v80, v114 dst_sel:WORD_1 dst_unused:UNUSED_PRESERVE src0_sel:WORD_1
    v_exp_f16_sdwa v81, v115 dst_sel:WORD_1 dst_unused:UNUSED_PRESERVE src0_sel:WORD_1
    v_exp_f16_sdwa v82, v118 dst_sel:WORD_1 dst_unused:UNUSED_PRESERVE src0_sel:WORD_1
    v_exp_f16_sdwa v83, v119 dst_sel:WORD_1 dst_unused:UNUSED_PRESERVE src0_sel:WORD_1
    v_pk_add_f16 v80, v80, 1.0 op_sel_hi:[1,0]
    v_pk_add_f16 v81, v81, 1.0 op_sel_hi:[1,0]
    v_pk_add_f16 v82, v82, 1.0 op_sel_hi:[1,0]
    v_pk_add_f16 v83, v83, 1.0 op_sel_hi:[1,0]
    v_rcp_f16_sdwa v80, v80 dst_sel:WORD_0 dst_unused:UNUSED_PRESERVE src0_sel:WORD_0
    v_rcp_f16_sdwa v81, v81 dst_sel:WORD_0 dst_unused:UNUSED_PRESERVE src0_sel:WORD_0
    v_rcp_f16_sdwa v82, v82 dst_sel:WORD_0 dst_unused:UNUSED_PRESERVE src0_sel:WORD_0
    v_rcp_f16_sdwa v83, v83 dst_sel:WORD_0 dst_unused:UNUSED_PRESERVE src0_sel:WORD_0
    v_rcp_f16_sdwa v80, v80 dst_sel:WORD_1 dst_unused:UNUSED_PRESERVE src0_sel:WORD_1
    v_rcp_f16_sdwa v81, v81 dst_sel:WORD_1 dst_unused:UNUSED_PRESERVE src0_sel:WORD_1
    v_rcp_f16_sdwa v82, v82 dst_sel:WORD_1 dst_unused:UNUSED_PRESERVE src0_sel:WORD_1
    v_rcp_f16_sdwa v83, v83 dst_sel:WORD_1 dst_unused:UNUSED_PRESERVE src0_sel:WORD_1
    v_pk_mul_f16 v114, v114, v80
    v_pk_mul_f16 v115, v115, v81
    v_pk_mul_f16 v118, v118, v82
    v_pk_mul_f16 v119, v119, v83
    s_branch L_blkt1
L_skipt1:
    v_mov_b32 v114, 0
    v_mov_b32 v115, 0
    v_mov_b32 v118, 0
    v_mov_b32 v119, 0
L_blkt1:
    s_waitcnt lgkmcnt(0)
    s_nop 1
    v_mfma_f32_32x32x16_f16 v[16:31], v[112:115], v[88:91], v[16:31]
    v_mfma_f32_32x32x16_f16 v[32:47], v[116:119], v[88:91], v[32:47]
    s_sub_u32 s81, s81, 16
    s_sub_u32 s90, s90, 1
    s_cmp_gt_u32 s90, 3
    s_cbranch_scc1 L_prt1
    s_setprio 2
    s_cmp_eq_u32 s90, 3
    s_cbranch_scc1 L_prt1
    s_setprio 1
    s_cmp_eq_u32 s90, 2
    s_cbranch_scc1 L_prt1
    s_setprio 0
L_prt1:
    s_cmp_lg_u32 s90, 0
    s_cbranch_scc1 L_tile_loop
L_tiles_done:
    s_waitcnt vmcnt(0)
    s_setprio 3
    s_cmp_eq_u32 s63, 0
    s_cbranch_scc0 L_slow_next
L_final:
    s_memrealtime s[6:7]
    v_and_b32 v9, 31, v0
    v_lshrrev_b32 v10, 5, v0
    s_cmp_eq_u32 s61, 3
    s_cbranch_scc1 L_f_flush3
    s_cmp_eq_u32 s61, 0
    s_cbranch_scc0 L_f_flush
    s_lshl_b32 s64, s62, 13
    s_add_u32 s64, s64, 12582912
    s_add_u32 s65, s64, 4096
    v_lshlrev_b32 v8, 4, v0
    buffer_load_dwordx4 v[80:83], v8, s[40:43], s64 offen offset:0 sc1
    buffer_load_dwordx4 v[84:87], v8, s[40:43], s64 offen offset:1024 sc1
    buffer_load_dwordx4 v[88:91], v8, s[40:43], s64 offen offset:2048 sc1
    buffer_load_dwordx4 v[92:95], v8, s[40:43], s64 offen offset:3072 sc1
    buffer_load_dwordx4 v[96:99], v8, s[40:43], s65 offen offset:0 sc1
    buffer_load_dwordx4 v[100:103], v8, s[40:43], s65 offen offset:1024 sc1
    buffer_load_dwordx4 v[104:107], v8, s[40:43], s65 offen offset:2048 sc1
    buffer_load_dwordx4 v[108:111], v8, s[40:43], s65 offen offset:3072 sc1
L_f_flush:
    s_mul_i32 s64, s76, 5
    s_sub_u32 s64, s64, 3
    s_add_u32 s65, s87, 1024
    v_lshrrev_b32 v14, 3, v9
    v_and_b32 v13, 7, v9
    v_mad_u32_u24 v13, v14, 5, v13
    v_mov_b32 v14, -8
    v_mov_b32 v15, s65
    s_mov_b32 exec_lo, 0xff
    s_mov_b32 exec_hi, 0xff
    v_mov_b32 v14, s64
    v_mov_b32 v15, s87
    s_mov_b64 exec, -1
    v_add_u32 v13, v14, v13
    v_lshl_add_u32 v15, v10, 3, v15
    v_bfe_u32 v14, v13, 2, 2
    v_lshl_add_u32 v15, v14, 6, v15
    v_and_b32 v13, 3, v13
    v_mul_u32_u24 v13, 0x110, v13
    v_add_u32 v13, v13, v15
    s_branch L_f_wr
L_f_flush3:
    v_mov_b32 v13, v126
L_f_wr:
    s_mov_b32 exec_lo, 0xf8f8f8f8
    s_mov_b32 exec_hi, 0xf8f8f8f8
    v_xor_b32 v49, 16, v13
    v_xor_b32 v50, 32, v13
    v_xor_b32 v51, 48, v13
    v_cvt_pk_bf16_f32 v16, v16, v17
    v_cvt_pk_bf16_f32 v17, v18, v19
    v_cvt_pk_bf16_f32 v20, v20, v21
    v_cvt_pk_bf16_f32 v21, v22, v23
    ds_write_b64 v13, v[16:17] offset:0
    v_cvt_pk_bf16_f32 v24, v24, v25
    v_cvt_pk_bf16_f32 v25, v26, v27
    ds_write_b64 v49, v[20:21] offset:0
    v_cvt_pk_bf16_f32 v28, v28, v29
    v_cvt_pk_bf16_f32 v29, v30, v31
    ds_write_b64 v50, v[24:25] offset:0
    v_cvt_pk_bf16_f32 v32, v32, v33
    v_cvt_pk_bf16_f32 v33, v34, v35
    ds_write_b64 v51, v[28:29] offset:0
    v_cvt_pk_bf16_f32 v36, v36, v37
    v_cvt_pk_bf16_f32 v37, v38, v39
    ds_write_b64 v13, v[32:33] offset:2048
    v_cvt_pk_bf16_f32 v40, v40, v41
    v_cvt_pk_bf16_f32 v41, v42, v43
    ds_write_b64 v49, v[36:37] offset:2048
    v_cvt_pk_bf16_f32 v44, v44, v45
    v_cvt_pk_bf16_f32 v45, v46, v47
    ds_write_b64 v50, v[40:41] offset:2048
    ds_write_b64 v51, v[44:45] offset:2048
    s_mov_b64 exec, -1
    s_mul_i32 s79, s2, 40
    s_cmp_eq_u32 s61, 2
    s_cbranch_scc1 L_f_roleC
    s_cmp_eq_u32 s61, 1
    s_cbranch_scc1 L_f_roleB
    s_cmp_eq_u32 s61, 0
    s_cbranch_scc0 L_f_bar
    v_xor_b32 v15, 0, v125
    ds_read_b64 v[112:113], v15
    v_xor_b32 v15, 16, v125
    ds_read_b64 v[114:115], v15
    v_xor_b32 v15, 32, v125
    ds_read_b64 v[116:117], v15
    v_xor_b32 v15, 48, v125
    ds_read_b64 v[118:119], v15
    s_mov_b32 s83, 0xffff0000
    s_waitcnt lgkmcnt(3)
    v_lshlrev_b32 v52, 16, v112
    v_and_b32 v53, s83, v112
    v_lshlrev_b32 v54, 16, v113
    v_and_b32 v55, s83, v113
    s_waitcnt lgkmcnt(2)
    v_lshlrev_b32 v56, 16, v114
    v_and_b32 v57, s83, v114
    v_lshlrev_b32 v58, 16, v115
    v_and_b32 v59, s83, v115
    s_waitcnt lgkmcnt(1)
    v_lshlrev_b32 v60, 16, v116
    v_and_b32 v61, s83, v116
    v_lshlrev_b32 v62, 16, v117
    v_and_b32 v63, s83, v117
    s_waitcnt lgkmcnt(0)
    v_lshlrev_b32 v120, 16, v118
    v_and_b32 v121, s83, v118
    v_lshlrev_b32 v122, 16, v119
    v_and_b32 v123, s83, v119
    s_branch L_f_bar
L_f_roleB:
    s_lshl_b32 s64, s62, 13
    s_add_u32 s64, s64, 12582912
    s_add_u32 s65, s64, 4096
    v_lshlrev_b32 v8, 4, v0
    buffer_load_dwordx4 v[80:83], v8, s[40:43], s64 offen offset:0 sc1
    buffer_load_dwordx4 v[84:87], v8, s[40:43], s64 offen offset:1024 sc1
    buffer_load_dwordx4 v[88:91], v8, s[40:43], s64 offen offset:2048 sc1
    buffer_load_dwordx4 v[92:95], v8, s[40:43], s64 offen offset:3072 sc1
    buffer_load_dwordx4 v[96:99], v8, s[40:43], s65 offen offset:0 sc1
    buffer_load_dwordx4 v[100:103], v8, s[40:43], s65 offen offset:1024 sc1
    buffer_load_dwordx4 v[104:107], v8, s[40:43], s65 offen offset:2048 sc1
    buffer_load_dwordx4 v[108:111], v8, s[40:43], s65 offen offset:3072 sc1
    v_xor_b32 v13, 0, v125
    ds_read_u16 v112, v13 offset:0
    v_xor_b32 v13, 16, v125
    ds_read_u16 v113, v13 offset:256
    v_xor_b32 v13, 32, v125
    ds_read_u16 v114, v13 offset:512
    v_xor_b32 v13, 48, v125
    ds_read_u16 v115, v13 offset:768
    s_waitcnt lgkmcnt(3)
    v_lshlrev_b32 v112, 16, v112
    s_waitcnt lgkmcnt(2)
    v_lshlrev_b32 v113, 16, v113
    s_waitcnt lgkmcnt(1)
    v_lshlrev_b32 v114, 16, v114
    s_waitcnt lgkmcnt(0)
    v_lshlrev_b32 v115, 16, v115
    s_setprio 2
    s_branch L_f_bar
L_f_roleC:
    v_lshlrev_b32 v8, 4, v10
    v_add_u32 v8, 163520, v8
    ds_read_b128 v[80:83], v8 offset:0
    ds_read_b128 v[84:87], v8 offset:32
    ds_read_b128 v[88:91], v8 offset:64
    ds_read_b128 v[92:95], v8 offset:96
    ds_read_b128 v[96:99], v8 offset:128
    ds_read_b128 v[100:103], v8 offset:160
    ds_read_b128 v[104:107], v8 offset:192
    ds_read_b128 v[108:111], v8 offset:224
    s_setprio 2
    v_and_b32 v8, 15, v9
    v_min_u32 v8, 14, v8
    v_mul_u32_u24 v14, 52, v8
    v_lshrrev_b32 v14, 8, v14
    v_lshrrev_b32 v15, 4, v9
    s_lshl_b32 s64, s62, 1
    v_add_u32 v15, s64, v15
    v_sub_u32 v13, v15, v14
    v_mad_u32_u24 v13, v13, 5, v8
    v_and_b32 v13, 63, v13
    v_add_u32 v14, 1, v14
    v_lshlrev_b32 v8, 4, v13
    v_lshl_add_u32 v8, v14, 2, v8
    v_add_u32 v8, 161788, v8
    ds_read_b32 v112, v8
    v_add_u32 v11, s79, v13
    v_mul_u32_u24 v11, 6, v11
    v_lshl_add_u32 v11, v14, 1, v11
    v_subrev_u32 v11, 2, v11
L_f_bar:
    s_waitcnt lgkmcnt(0)
L_guard:
    s_sub_u32 s64, s6, s92
    s_cmp_ge_u32 s64, 800
    s_cbranch_scc1 L_guard_ok
    s_sleep 8
    s_memrealtime s[6:7]
    s_waitcnt lgkmcnt(0)
    s_branch L_guard
L_guard_ok:
    s_barrier
    s_cmp_eq_u32 s61, 3
    s_cbranch_scc1 L_end
    v_xor_b32 v8, 32, v126
    ds_read_b128 v[16:19], v126 offset:0
    ds_read_b128 v[20:23], v8 offset:0
    ds_read_b128 v[24:27], v126 offset:2048
    ds_read_b128 v[28:31], v8 offset:2048
    ds_read_b128 v[32:35], v126 offset:4096
    ds_read_b128 v[36:39], v8 offset:4096
    ds_read_b128 v[40:43], v126 offset:6144
    ds_read_b128 v[44:47], v8 offset:6144
    s_mov_b32 s82, 0xbf317218
    s_mul_i32 s79, s2, 40
    s_mov_b32 s83, 0xffff0000
    s_waitcnt vmcnt(0)
    s_cmp_eq_u32 s61, 2
    s_cbranch_scc1 L_f_C
    s_cmp_eq_u32 s61, 1
    s_cbranch_scc1 L_f_B
    s_waitcnt lgkmcnt(7)
    v_mfma_f32_32x32x16_bf16 v[64:79], v[80:83], v[16:19], v[64:79]
    s_waitcnt lgkmcnt(6)
    v_mfma_f32_32x32x16_bf16 v[64:79], v[84:87], v[20:23], v[64:79]
    s_waitcnt lgkmcnt(5)
    v_mfma_f32_32x32x16_bf16 v[64:79], v[88:91], v[24:27], v[64:79]
    s_waitcnt lgkmcnt(4)
    v_mfma_f32_32x32x16_bf16 v[64:79], v[92:95], v[28:31], v[64:79]
    s_waitcnt lgkmcnt(3)
    v_mfma_f32_32x32x16_bf16 v[64:79], v[96:99], v[32:35], v[64:79]
    s_waitcnt lgkmcnt(2)
    v_mfma_f32_32x32x16_bf16 v[64:79], v[100:103], v[36:39], v[64:79]
    s_waitcnt lgkmcnt(1)
    v_mfma_f32_32x32x16_bf16 v[64:79], v[104:107], v[40:43], v[64:79]
    s_waitcnt lgkmcnt(0)
    v_mfma_f32_32x32x16_bf16 v[64:79], v[108:111], v[44:47], v[64:79]
    s_setprio 0
    s_nop 7
    s_nop 3
    v_exp_f32 v48, v64
    v_exp_f32 v49, v65
    v_exp_f32 v50, v66
    v_exp_f32 v51, v67
    v_add_f32 v48, 1.0, v48
    v_add_f32 v49, 1.0, v49
    v_add_f32 v50, 1.0, v50
    v_add_f32 v51, 1.0, v51
    v_rcp_f32 v48, v48
    v_rcp_f32 v49, v49
    v_rcp_f32 v50, v50
    v_rcp_f32 v51, v51
    v_mul_f32 v64, v64, v48
    v_mul_f32 v65, v65, v49
    v_mul_f32 v66, v66, v50
    v_mul_f32 v67, v67, v51
    v_fma_f32 v64, v64, s82, v52
    v_fma_f32 v65, v65, s82, v53
    v_fma_f32 v66, v66, s82, v54
    v_fma_f32 v67, v67, s82, v55
    v_cvt_pk_bf16_f32 v64, v64, v65
    v_cvt_pk_bf16_f32 v65, v66, v67
    buffer_store_dwordx2 v[64:65], v124, s[32:35], 0 offen offset:0
    v_exp_f32 v48, v68
    v_exp_f32 v49, v69
    v_exp_f32 v50, v70
    v_exp_f32 v51, v71
    v_add_f32 v48, 1.0, v48
    v_add_f32 v49, 1.0, v49
    v_add_f32 v50, 1.0, v50
    v_add_f32 v51, 1.0, v51
    v_rcp_f32 v48, v48
    v_rcp_f32 v49, v49
    v_rcp_f32 v50, v50
    v_rcp_f32 v51, v51
    v_mul_f32 v68, v68, v48
    v_mul_f32 v69, v69, v49
    v_mul_f32 v70, v70, v50
    v_mul_f32 v71, v71, v51
    v_fma_f32 v68, v68, s82, v56
    v_fma_f32 v69, v69, s82, v57
    v_fma_f32 v70, v70, s82, v58
    v_fma_f32 v71, v71, s82, v59
    v_cvt_pk_bf16_f32 v68, v68, v69
    v_cvt_pk_bf16_f32 v69, v70, v71
    buffer_store_dwordx2 v[68:69], v124, s[32:35], 0 offen offset:16
    v_exp_f32 v48, v72
    v_exp_f32 v49, v73
    v_exp_f32 v50, v74
    v_exp_f32 v51, v75
    v_add_f32 v48, 1.0, v48
    v_add_f32 v49, 1.0, v49
    v_add_f32 v50, 1.0, v50
    v_add_f32 v51, 1.0, v51
    v_rcp_f32 v48, v48
    v_rcp_f32 v49, v49
    v_rcp_f32 v50, v50
    v_rcp_f32 v51, v51
    v_mul_f32 v72, v72, v48
    v_mul_f32 v73, v73, v49
    v_mul_f32 v74, v74, v50
    v_mul_f32 v75, v75, v51
    v_fma_f32 v72, v72, s82, v60
    v_fma_f32 v73, v73, s82, v61
    v_fma_f32 v74, v74, s82, v62
    v_fma_f32 v75, v75, s82, v63
    v_cvt_pk_bf16_f32 v72, v72, v73
    v_cvt_pk_bf16_f32 v73, v74, v75
    buffer_store_dwordx2 v[72:73], v124, s[32:35], 0 offen offset:32
    v_exp_f32 v48, v76
    v_exp_f32 v49, v77
    v_exp_f32 v50, v78
    v_exp_f32 v51, v79
    v_add_f32 v48, 1.0, v48
    v_add_f32 v49, 1.0, v49
    v_add_f32 v50, 1.0, v50
    v_add_f32 v51, 1.0, v51
    v_rcp_f32 v48, v48
    v_rcp_f32 v49, v49
    v_rcp_f32 v50, v50
    v_rcp_f32 v51, v51
    v_mul_f32 v76, v76, v48
    v_mul_f32 v77, v77, v49
    v_mul_f32 v78, v78, v50
    v_mul_f32 v79, v79, v51
    v_fma_f32 v76, v76, s82, v120
    v_fma_f32 v77, v77, s82, v121
    v_fma_f32 v78, v78, s82, v122
    v_fma_f32 v79, v79, s82, v123
    v_cvt_pk_bf16_f32 v76, v76, v77
    v_cvt_pk_bf16_f32 v77, v78, v79
    buffer_store_dwordx2 v[76:77], v124, s[32:35], 0 offen offset:48
    s_branch L_end
L_f_B:
    v_mov_b32 v48, v120
    v_mov_b32 v49, v121
    v_mov_b32 v50, v122
    v_mov_b32 v51, v123
    s_nop 1
    s_waitcnt lgkmcnt(7)
    v_mfma_f32_32x32x16_bf16 v[48:63], v[16:19], v[80:83], v[48:63]
    s_waitcnt lgkmcnt(6)
    v_mfma_f32_32x32x16_bf16 v[48:63], v[20:23], v[84:87], v[48:63]
    s_waitcnt lgkmcnt(5)
    v_mfma_f32_32x32x16_bf16 v[48:63], v[24:27], v[88:91], v[48:63]
    s_waitcnt lgkmcnt(4)
    v_mfma_f32_32x32x16_bf16 v[48:63], v[28:31], v[92:95], v[48:63]
    s_waitcnt lgkmcnt(3)
    v_mfma_f32_32x32x16_bf16 v[48:63], v[32:35], v[96:99], v[48:63]
    s_waitcnt lgkmcnt(2)
    v_mfma_f32_32x32x16_bf16 v[48:63], v[36:39], v[100:103], v[48:63]
    s_waitcnt lgkmcnt(1)
    v_mfma_f32_32x32x16_bf16 v[48:63], v[40:43], v[104:107], v[48:63]
    s_waitcnt lgkmcnt(0)
    v_mfma_f32_32x32x16_bf16 v[48:63], v[44:47], v[108:111], v[48:63]
    s_nop 7
    s_nop 3
    v_exp_f32 v64, v48
    v_exp_f32 v65, v49
    v_exp_f32 v66, v50
    v_exp_f32 v67, v51
    v_add_f32 v64, 1.0, v64
    v_add_f32 v65, 1.0, v65
    v_add_f32 v66, 1.0, v66
    v_add_f32 v67, 1.0, v67
    v_rcp_f32 v64, v64
    v_rcp_f32 v65, v65
    v_rcp_f32 v66, v66
    v_rcp_f32 v67, v67
    v_mul_f32 v48, v48, v64
    v_mul_f32 v49, v49, v65
    v_mul_f32 v50, v50, v66
    v_mul_f32 v51, v51, v67
    v_fma_f32 v48, v48, s82, v112
    v_fma_f32 v49, v49, s82, v113
    v_fma_f32 v50, v50, s82, v114
    v_fma_f32 v51, v51, s82, v115
    v_cvt_pk_bf16_f32 v72, v48, v49
    v_cvt_pk_bf16_f32 v74, v50, v51
    buffer_store_short v72, v124, s[32:35], 0 offen offset:0
    buffer_store_short_d16_hi v72, v124, s[32:35], 0 offen offset:256
    buffer_store_short v74, v124, s[32:35], 0 offen offset:512
    buffer_store_short_d16_hi v74, v124, s[32:35], 0 offen offset:768
    s_branch L_end
L_f_C:
    s_waitcnt lgkmcnt(7)
    v_mfma_f32_32x32x16_bf16 v[48:63], v[80:83], v[16:19], 0
    s_waitcnt lgkmcnt(6)
    v_mfma_f32_32x32x16_bf16 v[48:63], v[84:87], v[20:23], v[48:63]
    s_waitcnt lgkmcnt(5)
    v_mfma_f32_32x32x16_bf16 v[48:63], v[88:91], v[24:27], v[48:63]
    s_waitcnt lgkmcnt(4)
    v_mfma_f32_32x32x16_bf16 v[48:63], v[92:95], v[28:31], v[48:63]
    s_waitcnt lgkmcnt(3)
    v_mfma_f32_32x32x16_bf16 v[48:63], v[96:99], v[32:35], v[48:63]
    s_waitcnt lgkmcnt(2)
    v_mfma_f32_32x32x16_bf16 v[48:63], v[100:103], v[36:39], v[48:63]
    s_waitcnt lgkmcnt(1)
    v_mfma_f32_32x32x16_bf16 v[48:63], v[104:107], v[40:43], v[48:63]
    s_waitcnt lgkmcnt(0)
    v_mfma_f32_32x32x16_bf16 v[48:63], v[108:111], v[44:47], v[48:63]
    s_nop 7
    s_nop 3
    v_fma_f32 v48, v48, s82, v112
    v_cvt_pk_bf16_f32 v48, v48, v48
    s_mov_b32 exec_lo, 0x7fff7fff
    s_mov_b32 exec_hi, 0
    buffer_store_short v48, v11, s[36:39], 0 offen
L_end:
L_end2:
    s_endpgm
L_slow_init:
    s_mov_b32 s91, 0
    s_mov_b32 s63, 1
    s_mov_b32 s85, 0
    s_mov_b32 s86, 0
    s_and_b32 s67, s67, 2
    s_cmp_eq_u32 s67, 0
    s_cbranch_scc1 L_slow_pass
    s_mov_b32 s80, 0
L_fb_loop:
    s_waitcnt vmcnt(0) lgkmcnt(0)
    s_barrier
    s_cmp_lt_u32 s60, 8
    s_cbranch_scc1 L_fb_idle
    v_lshrrev_b32 v16, 2, v0
    v_lshlrev_b32 v16, 8, v16
    v_and_b32 v21, 3, v0
    v_lshl_add_u32 v16, v21, 4, v16
    s_lshl_b32 s64, s62, 6
    v_add_u32 v16, s64, v16
    v_lshrrev_b32 v21, 4, v0
    v_and_b32 v22, 15, v0
    v_xor_b32 v22, v22, v21
    s_and_b32 s64, s56, 1
    s_lshl_b32 s64, s64, 3
    v_xor_b32 v22, s64, v22
    v_lshlrev_b32 v22, 4, v22
    v_lshl_add_u32 v18, v21, 8, v22
    v_xor_b32 v19, 64, v18
    s_lshl_b32 s64, s62, 13
    s_lshl_b32 s65, s57, 12
    s_add_u32 s64, s64, s65
    s_add_u32 s64, s64, 69632
    s_lshl_b32 s65, s57, 14
    s_add_u32 s65, s65, 32768
    s_lshl_b32 s67, s56, 11
    s_lshl_b32 s96, s80, 14
    s_add_u32 s96, s96, s67
    s_add_u32 m0, s67, 102400
    s_add_u32 s97, s96, 1024
    buffer_load_dwordx4 v18, s[8:11], s96 offen lds
    s_add_u32 m0, s67, 103424
    s_nop 0
    buffer_load_dwordx4 v19, s[8:11], s97 offen lds
    s_add_u32 m0, s64, 0
    s_add_u32 s66, s65, 0
    buffer_load_dwordx4 v16, s[48:51], s66 offen lds
    s_add_u32 m0, s64, 1024
    s_add_u32 s66, s65, 4096
    buffer_load_dwordx4 v16, s[48:51], s66 offen lds
    s_add_u32 m0, s64, 2048
    s_add_u32 s66, s65, 8192
    buffer_load_dwordx4 v16, s[48:51], s66 offen lds
    s_add_u32 m0, s64, 3072
    s_add_u32 s66, s65, 12288
    buffer_load_dwordx4 v16, s[48:51], s66 offen lds
    v_lshrrev_b32 v21, 5, v0
    v_bfe_u32 v22, v0, 2, 2
    v_lshl_add_u32 v17, v21, 3, v22
    v_lshlrev_b32 v17, 6, v17
    v_bfe_u32 v21, v0, 4, 1
    v_lshl_add_u32 v17, v21, 5, v17
    v_and_b32 v21, 3, v0
    v_lshl_add_u32 v17, v21, 3, v17
    s_lshl_b32 s64, s62, 13
    s_add_u32 s64, s64, 69632
    v_add_u32 v17, s64, v17
    v_and_b32 v21, 31, v0
    v_lshrrev_b32 v22, 5, v0
    v_and_b32 v19, 15, v0
    v_xor_b32 v19, v19, v22
    v_lshlrev_b32 v19, 4, v19
    v_lshl_add_u32 v19, v21, 8, v19
    s_lshl_b32 s64, s57, 13
    s_add_u32 s64, s64, 102400
    v_add_u32 v19, s64, v19
    s_lshl_b32 s64, s56, 11
    s_add_u32 s64, s64, 118784
    v_bfe_u32 v18, v0, 2, 2
    v_lshlrev_b32 v18, 4, v18
    v_lshl_add_u32 v18, v21, 6, v18
    v_lshl_add_u32 v18, v22, 3, v18
    v_add_u32 v18, s64, v18
    v_lshrrev_b32 v21, 2, v0
    v_and_b32 v22, 3, v0
    v_bfe_u32 v16, v0, 4, 2
    v_xor_b32 v16, v16, v22
    v_lshlrev_b32 v16, 4, v16
    v_lshl_add_u32 v16, v21, 6, v16
    v_add_u32 v16, s64, v16
    v_lshlrev_b32 v20, 4, v22
    v_lshl_add_u32 v20, v21, 8, v20
    s_lshl_b32 s64, s80, 14
    s_lshl_b32 s65, s57, 13
    s_add_u32 s64, s64, s65
    s_lshl_b32 s65, s62, 6
    s_add_u32 s95, s64, s65
    s_add_u32 s95, s95, 8388608
    s_waitcnt vmcnt(0) lgkmcnt(0)
    s_barrier
    v_xor_b32 v21, 0, v19
    ds_read_b128 v[56:59], v21
    ds_read_b64_tr_b16 v[24:25], v17 offset:0
    ds_read_b64_tr_b16 v[26:27], v17 offset:256
    v_xor_b32 v21, 32, v19
    ds_read_b128 v[60:63], v21
    ds_read_b64_tr_b16 v[28:29], v17 offset:1024
    ds_read_b64_tr_b16 v[30:31], v17 offset:1280
    v_xor_b32 v21, 64, v19
    ds_read_b128 v[64:67], v21
    ds_read_b64_tr_b16 v[32:33], v17 offset:2048
    ds_read_b64_tr_b16 v[34:35], v17 offset:2304
    v_xor_b32 v21, 96, v19
    ds_read_b128 v[68:71], v21
    ds_read_b64_tr_b16 v[36:37], v17 offset:3072
    ds_read_b64_tr_b16 v[38:39], v17 offset:3328
    v_xor_b32 v21, 128, v19
    ds_read_b128 v[72:75], v21
    ds_read_b64_tr_b16 v[40:41], v17 offset:4096
    ds_read_b64_tr_b16 v[42:43], v17 offset:4352
    v_xor_b32 v21, 160, v19
    ds_read_b128 v[76:79], v21
    ds_read_b64_tr_b16 v[44:45], v17 offset:5120
    ds_read_b64_tr_b16 v[46:47], v17 offset:5376
    v_xor_b32 v21, 192, v19
    ds_read_b128 v[80:83], v21
    ds_read_b64_tr_b16 v[48:49], v17 offset:6144
    ds_read_b64_tr_b16 v[50:51], v17 offset:6400
    v_xor_b32 v21, 224, v19
    ds_read_b128 v[84:87], v21
    ds_read_b64_tr_b16 v[52:53], v17 offset:7168
    ds_read_b64_tr_b16 v[54:55], v17 offset:7424
    s_waitcnt lgkmcnt(15)
    v_mfma_f32_32x32x16_bf16 v[88:103], v[24:27], v[56:59], 0
    s_waitcnt lgkmcnt(15)
    v_mfma_f32_32x32x16_bf16 v[88:103], v[28:31], v[60:63], v[88:103]
    s_waitcnt lgkmcnt(15)
    v_mfma_f32_32x32x16_bf16 v[88:103], v[32:35], v[64:67], v[88:103]
    s_waitcnt lgkmcnt(12)
    v_mfma_f32_32x32x16_bf16 v[88:103], v[36:39], v[68:71], v[88:103]
    s_waitcnt lgkmcnt(9)
    v_mfma_f32_32x32x16_bf16 v[88:103], v[40:43], v[72:75], v[88:103]
    s_waitcnt lgkmcnt(6)
    v_mfma_f32_32x32x16_bf16 v[88:103], v[44:47], v[76:79], v[88:103]
    s_waitcnt lgkmcnt(3)
    v_mfma_f32_32x32x16_bf16 v[88:103], v[48:51], v[80:83], v[88:103]
    s_waitcnt lgkmcnt(0)
    v_mfma_f32_32x32x16_bf16 v[88:103], v[52:55], v[84:87], v[88:103]
    s_mov_b32 s65, 0xbfb8aa3b
    s_nop 7
    s_nop 3
    v_mul_f32 v88, s65, v88
    v_mul_f32 v89, s65, v89
    v_mul_f32 v90, s65, v90
    v_mul_f32 v91, s65, v91
    v_cvt_pk_bf16_f32 v88, v88, v89
    v_cvt_pk_bf16_f32 v89, v90, v91
    v_xor_b32 v21, 0, v18
    ds_write_b64 v21, v[88:89]
    v_mul_f32 v92, s65, v92
    v_mul_f32 v93, s65, v93
    v_mul_f32 v94, s65, v94
    v_mul_f32 v95, s65, v95
    v_cvt_pk_bf16_f32 v92, v92, v93
    v_cvt_pk_bf16_f32 v93, v94, v95
    v_xor_b32 v21, 16, v18
    ds_write_b64 v21, v[92:93]
    v_mul_f32 v96, s65, v96
    v_mul_f32 v97, s65, v97
    v_mul_f32 v98, s65, v98
    v_mul_f32 v99, s65, v99
    v_cvt_pk_bf16_f32 v96, v96, v97
    v_cvt_pk_bf16_f32 v97, v98, v99
    v_xor_b32 v21, 32, v18
    ds_write_b64 v21, v[96:97]
    v_mul_f32 v100, s65, v100
    v_mul_f32 v101, s65, v101
    v_mul_f32 v102, s65, v102
    v_mul_f32 v103, s65, v103
    v_cvt_pk_bf16_f32 v100, v100, v101
    v_cvt_pk_bf16_f32 v101, v102, v103
    v_xor_b32 v21, 48, v18
    ds_write_b64 v21, v[100:101]
    s_waitcnt lgkmcnt(0)
    ds_read_b128 v[24:27], v16 offset:0
    ds_read_b128 v[28:31], v16 offset:1024
    s_add_u32 s65, s95, 4096
    s_waitcnt lgkmcnt(1)
    buffer_store_dwordx4 v[24:27], v20, s[40:43], s95 offen sc1
    s_waitcnt lgkmcnt(0)
    buffer_store_dwordx4 v[28:31], v20, s[40:43], s65 offen sc1
    s_branch L_fb_next
L_fb_idle:
    s_barrier
L_fb_next:
    s_add_u32 s80, s80, 1
    s_cmp_lt_u32 s80, 157
    s_cbranch_scc1 L_fb_loop
    s_waitcnt vmcnt(0) lgkmcnt(0)
    s_barrier
    s_cmp_ge_u32 s60, 4
    s_cbranch_scc1 L_slow_pass
    v_lshrrev_b32 v16, 2, v0
    v_lshlrev_b32 v16, 8, v16
    v_and_b32 v21, 3, v0
    v_lshl_add_u32 v16, v21, 4, v16
    s_lshl_b32 s64, s62, 6
    v_add_u32 v16, s64, v16
    s_lshl_b32 s66, s62, 13
    s_add_u32 s66, s66, 69632
    v_lshrrev_b32 v21, 5, v0
    v_bfe_u32 v22, v0, 2, 2
    v_lshl_add_u32 v17, v21, 3, v22
    v_lshlrev_b32 v17, 6, v17
    v_bfe_u32 v21, v0, 4, 1
    v_lshl_add_u32 v17, v21, 5, v17
    v_and_b32 v21, 3, v0
    v_lshl_add_u32 v17, v21, 3, v17
    v_add_u32 v17, s66, v17
    v_lshlrev_b32 v20, 4, v0
    s_add_u32 m0, s66, 0
    s_mov_b32 s65, 32768
    buffer_load_dwordx4 v16, s[52:55], s65 offen lds
    s_add_u32 m0, s66, 1024
    s_mov_b32 s65, 36864
    buffer_load_dwordx4 v16, s[52:55], s65 offen lds
    s_add_u32 m0, s66, 2048
    s_mov_b32 s65, 40960
    buffer_load_dwordx4 v16, s[52:55], s65 offen lds
    s_add_u32 m0, s66, 3072
    s_mov_b32 s65, 45056
    buffer_load_dwordx4 v16, s[52:55], s65 offen lds
    s_add_u32 m0, s66, 4096
    s_mov_b32 s65, 49152
    buffer_load_dwordx4 v16, s[52:55], s65 offen lds
    s_add_u32 m0, s66, 5120
    s_mov_b32 s65, 53248
    buffer_load_dwordx4 v16, s[52:55], s65 offen lds
    s_add_u32 m0, s66, 6144
    s_mov_b32 s65, 57344
    buffer_load_dwordx4 v16, s[52:55], s65 offen lds
    s_add_u32 m0, s66, 7168
    s_mov_b32 s65, 61440
    buffer_load_dwordx4 v16, s[52:55], s65 offen lds
    s_lshl_b32 s95, s62, 13
    s_add_u32 s95, s95, 12582912
    s_waitcnt vmcnt(0)
    ds_read_b64_tr_b16 v[24:25], v17 offset:0
    ds_read_b64_tr_b16 v[26:27], v17 offset:256
    ds_read_b64_tr_b16 v[28:29], v17 offset:1024
    ds_read_b64_tr_b16 v[30:31], v17 offset:1280
    ds_read_b64_tr_b16 v[32:33], v17 offset:2048
    ds_read_b64_tr_b16 v[34:35], v17 offset:2304
    ds_read_b64_tr_b16 v[36:37], v17 offset:3072
    ds_read_b64_tr_b16 v[38:39], v17 offset:3328
    ds_read_b64_tr_b16 v[40:41], v17 offset:4096
    ds_read_b64_tr_b16 v[42:43], v17 offset:4352
    ds_read_b64_tr_b16 v[44:45], v17 offset:5120
    ds_read_b64_tr_b16 v[46:47], v17 offset:5376
    ds_read_b64_tr_b16 v[48:49], v17 offset:6144
    ds_read_b64_tr_b16 v[50:51], v17 offset:6400
    ds_read_b64_tr_b16 v[52:53], v17 offset:7168
    ds_read_b64_tr_b16 v[54:55], v17 offset:7424
    s_waitcnt lgkmcnt(14)
    buffer_store_dwordx4 v[24:27], v20, s[40:43], s95 offen offset:0 sc1
    s_waitcnt lgkmcnt(12)
    buffer_store_dwordx4 v[28:31], v20, s[40:43], s95 offen offset:1024 sc1
    s_waitcnt lgkmcnt(10)
    buffer_store_dwordx4 v[32:35], v20, s[40:43], s95 offen offset:2048 sc1
    s_waitcnt lgkmcnt(8)
    buffer_store_dwordx4 v[36:39], v20, s[40:43], s95 offen offset:3072 sc1
    s_add_u32 s95, s95, 4096
    s_waitcnt lgkmcnt(6)
    buffer_store_dwordx4 v[40:43], v20, s[40:43], s95 offen offset:0 sc1
    s_waitcnt lgkmcnt(4)
    buffer_store_dwordx4 v[44:47], v20, s[40:43], s95 offen offset:1024 sc1
    s_waitcnt lgkmcnt(2)
    buffer_store_dwordx4 v[48:51], v20, s[40:43], s95 offen offset:2048 sc1
    s_waitcnt lgkmcnt(0)
    buffer_store_dwordx4 v[52:55], v20, s[40:43], s95 offen offset:3072 sc1
    s_branch L_slow_pass
L_slow_next:
    v_mov_b32 v8, 162468
    ds_read_b32 v9, v8
    s_waitcnt lgkmcnt(0)
    v_readfirstlane_b32 s86, v9
    s_nop 3
    s_cmp_lg_u32 s86, 0
    s_cbranch_scc1 L_slow_pass
L_slow_adv:
    s_add_u32 s85, s85, 1
    s_cmp_ge_u32 s85, 250
    s_cbranch_scc1 L_slow_fin
L_slow_pass:
    s_waitcnt vmcnt(0) lgkmcnt(0)
    s_barrier
    s_lshl_b32 s64, s60, 6
    v_add_u32 v15, s64, v0
    v_mov_b32 v116, 0
    v_mov_b32 v117, 0
    v_mov_b32 v118, 0
    v_mov_b32 v119, 0
    v_lshlrev_b32 v8, 4, v15
    ds_write_b128 v8, v[116:119] offset:0
    ds_write_b128 v8, v[116:119] offset:16384
    ds_write_b128 v8, v[116:119] offset:32768
    ds_write_b128 v8, v[116:119] offset:49152
    v_add_u32 v9, 65536, v8
    v_add_u32 v10, 158336, v8
    v_cmp_gt_u32 vcc, 256, v15
    v_cndmask_b32 v9, v10, v9, vcc
    v_cmp_gt_u32 vcc, 260, v15
    s_mov_b64 exec, vcc
    ds_write_b128 v9, v[116:119]
    s_mov_b64 exec, -1
    s_mul_i32 s64, s85, 2560
    s_mul_i32 s65, s85, 1280
    v_lshlrev_b32 v8, 2, v15
    v_lshlrev_b32 v9, 1, v15
    v_mov_b32 v104, -1
    v_mov_b32 v105, 0
    v_mov_b32 v90, 0
    v_mov_b32 v97, 0
    v_mov_b32 v109, 640
    v_cmp_gt_u32 s[70:71], v109, v15
    s_cmp_eq_u64 s[70:71], 0
    s_cbranch_scc1 L_slow_nold
    s_mov_b64 exec, s[70:71]
    buffer_load_dword v104, v8, s[24:27], s64 offen
    buffer_load_dword v105, v8, s[20:23], s64 offen
    buffer_load_ushort v97, v9, s[16:19], s65 offen
    v_add_u32 v109, 162560, v15
    ds_read_u8 v90, v109
    s_mov_b64 exec, -1
L_slow_nold:
    s_waitcnt vmcnt(0) lgkmcnt(0)
    s_barrier
    v_mul_u32_u24 v106, 52429, v104
    v_lshrrev_b32 v106, 21, v106
    v_mul_u32_u24 v107, 40, v106
    v_sub_u32 v107, v104, v107
    v_cmp_eq_u32 vcc, s2, v106
    s_and_b64 s[70:71], s[70:71], vcc
    s_cmp_eq_u32 s86, 0
    s_cbranch_scc1 L_slow_fresh
    v_cmp_ne_u32 vcc, 0, v90
    s_and_b64 s[70:71], s[70:71], vcc
L_slow_fresh:
    v_and_b32 v107, 63, v107
    v_min_u32 v107, 39, v107
    v_mul_u32_u24 v80, 52, v107
    v_lshrrev_b32 v80, 8, v80
    v_mul_u32_u24 v109, 5, v80
    v_sub_u32 v109, v107, v109
    v_and_b32 v105, 0x3fff, v105
    v_lshl_or_b32 v96, v107, 14, v105
    v_mov_b32 v124, v109
    s_mov_b32 s64, 162432
    v_lshl_add_u32 v109, v80, 2, s64
    v_mov_b32 v89, 1
    v_mov_b32 v90, 0
    v_mul_u32_u24 v106, 6, v105
    v_and_b32 v106, -4, v106
    s_mov_b64 s[72:73], 0
    s_mov_b64 s[96:97], 0
    s_mov_b64 s[98:99], 0
    s_cmp_eq_u64 s[70:71], 0
    s_cbranch_scc1 L_slow_nom
    s_mov_b64 exec, s[70:71]
    buffer_load_dwordx2 v[56:57], v106, s[12:15], 0 offen
    ds_add_rtn_u32 v108, v109, v89
    s_mov_b64 exec, -1
    v_mul_u32_u24 v80, 8704, v80
    s_waitcnt lgkmcnt(0)
    v_cmp_gt_u32 vcc, 136, v108
    v_lshl_add_u32 v80, v108, 6, v80
    v_bfe_u32 v108, v108, 2, 2
    v_lshl_add_u32 v80, v108, 4, v80
    v_xor_b32 v108, 16, v80
    s_andn2_b64 exec, s[70:71], vcc
    s_cbranch_execz L_s1_oks
    v_mov_b32 v90, 1
    v_mov_b32 v8, 162468
    ds_write_b32 v8, v89
L_s1_oks:
    s_and_b64 s[70:71], s[70:71], vcc
    s_mov_b64 exec, s[70:71]
    ds_write_b16 v108, v105 offset:0
    s_mov_b64 exec, -1
L_slow_nom:
    v_mov_b32 v109, 640
    v_cmp_gt_u32 vcc, v109, v15
    s_mov_b64 exec, vcc
    s_cbranch_execz L_slow_nopb
    v_add_u32 v109, 162560, v15
    ds_write_b8 v109, v90
L_slow_nopb:
    s_mov_b64 exec, -1
    s_branch L_st2
L_slow_fin:
    s_cmp_ge_u32 s60, 8
    s_cbranch_scc1 L_sf_nor
    v_and_b32 v8, 31, v0
    v_lshrrev_b32 v9, 5, v0
    s_mul_i32 s65, s2, 40
    s_cmp_eq_u32 s61, 0
    s_cbranch_scc0 L_far_bs
    v_and_b32 v10, 15, v8
    s_lshl_b32 s64, s62, 2
    v_xor_b32 v10, s64, v10
    v_lshlrev_b32 v10, 4, v10
    v_lshl_add_u32 v10, v8, 8, v10
    v_lshl_add_u32 v10, v9, 3, v10
    v_add_u32 v125, 151552, v10
    v_add_u32 v124, s65, v8
    v_lshlrev_b32 v124, 8, v124
    v_lshl_add_u32 v124, v9, 3, v124
    s_lshl_b32 s64, s62, 6
    v_add_u32 v124, s64, v124
    s_branch L_far_ds
L_far_bs:
    v_lshrrev_b32 v10, 3, v8
    s_lshl_b32 s64, s62, 2
    v_add_u32 v10, s64, v10
    v_lshlrev_b32 v11, 2, v9
    v_xor_b32 v10, v10, v11
    v_lshlrev_b32 v10, 4, v10
    v_lshl_add_u32 v10, v11, 8, v10
    v_and_b32 v9, 7, v8
    v_lshl_add_u32 v10, v9, 1, v10
    v_add_u32 v125, 159744, v10
    s_add_u32 s64, s65, 32
    v_add_u32 v124, s64, v11
    v_lshlrev_b32 v124, 8, v124
    v_lshl_add_u32 v124, v8, 1, v124
    s_lshl_b32 s64, s62, 6
    v_add_u32 v124, s64, v124
L_far_ds:
L_sf_nor:
    s_cmp_eq_u32 s84, 0
    s_cbranch_scc1 L_final_bar
    v_mov_b32 v16, 0
    v_mov_b32 v17, 0
    v_mov_b32 v18, 0
    v_mov_b32 v19, 0
    v_mov_b32 v20, 0
    v_mov_b32 v21, 0
    v_mov_b32 v22, 0
    v_mov_b32 v23, 0
    v_mov_b32 v24, 0
    v_mov_b32 v25, 0
    v_mov_b32 v26, 0
    v_mov_b32 v27, 0
    v_mov_b32 v28, 0
    v_mov_b32 v29, 0
    v_mov_b32 v30, 0
    v_mov_b32 v31, 0
    v_mov_b32 v32, 0
    v_mov_b32 v33, 0
    v_mov_b32 v34, 0
    v_mov_b32 v35, 0
    v_mov_b32 v36, 0
    v_mov_b32 v37, 0
    v_mov_b32 v38, 0
    v_mov_b32 v39, 0
    v_mov_b32 v40, 0
    v_mov_b32 v41, 0
    v_mov_b32 v42, 0
    v_mov_b32 v43, 0
    v_mov_b32 v44, 0
    v_mov_b32 v45, 0
    v_mov_b32 v46, 0
    v_mov_b32 v47, 0
L_final_bar:
    s_barrier
    s_branch L_final
.section .rodata,"a"
.p2align 6
.amdhsa_kernel standalone__cheap_equivariant_egnn__graph_kernel
  .amdhsa_next_free_vgpr 128
  .amdhsa_next_free_sgpr 102
  .amdhsa_accum_offset 128
  .amdhsa_group_segment_fixed_size 0
  .amdhsa_kernarg_size 88
  .amdhsa_user_sgpr_count 2
  .amdhsa_user_sgpr_kernarg_segment_ptr 1
  .amdhsa_system_sgpr_workgroup_id_x 1
.end_amdhsa_kernel
```
